```python
import torch

def _softmax(x, axis=-1):
    return torch.softmax(x, dim=axis)
def _gelu(x):
    return torch.nn.functional.gelu(x, approximate="tanh")
def _silu(x):
    return torch.nn.functional.silu(x)
def _sigmoid(x):
    return torch.sigmoid(x)
def _layernorm(x, axis=-1, eps=1e-5):
    m = x.mean(dim=axis, keepdim=True)
    v = x.var(dim=axis, keepdim=True, unbiased=False)
    return (x - m) / torch.sqrt(v + eps)
def _scatter_add(tgt, idx, src, axis=0):
    return tgt.clone().index_add_(axis, idx, src)
def _segment_sum(src, seg, n):
    out = torch.zeros((n,) + src.shape[1:], dtype=src.dtype)
    return out.index_add_(0, seg, src)
def _pad(x, pw):
    flat = tuple(v for pair in reversed(pw) for v in pair)
    return torch.nn.functional.pad(x, flat)

kernel_name = 'sequential_preLN__spectral_gfnet__mixer_channel_mlp__prompt'

def setup_inputs():

    _w = (lambda a: (lambda t: t.to(torch.bfloat16) if t.is_floating_point() else t)(torch.as_tensor(a)))
    def _A_setup():
        B, S, D = 1, 2048, 512
        Df = D // 2 + 1
        return {
            "x": _w((lambda *s: torch.randn(*s, dtype=torch.bfloat16) * 0.05)(B, S, D)),
            "w_r": _w((lambda *s: torch.randn(*s, dtype=torch.bfloat16) * 0.8)(S, Df) * 0.02),
            "w_i": _w((lambda *s: torch.randn(*s, dtype=torch.bfloat16) * 0.8)(S, Df) * 0.02),
        }
    _A_in = _A_setup()

    def _B_setup():
        B, S, D, F = 1, 2048, 512, 1792
        return {
            "x": _w((lambda *s: torch.randn(*s, dtype=torch.bfloat16) * 0.05)(B, S, D)),
            "w1": _w((lambda *s: torch.randn(*s, dtype=torch.bfloat16) * 0.8)(D, F) * (D ** -0.5)),
            "b1": _w((lambda *s: torch.randn(*s, dtype=torch.bfloat16) * 0.4)(F)),
            "w2": _w((lambda *s: torch.randn(*s, dtype=torch.bfloat16) * 0.05)(F, D) * (F ** -0.5)),
            "b2": _w((lambda *s: torch.randn(*s, dtype=torch.bfloat16) * 0.05)(D)),
        }
    _B_in = _B_setup()

    return {
        "A_x": _A_in["x"],
        "A_w_r": _A_in["w_r"],
        "A_w_i": _A_in["w_i"],
        "B_x": _B_in["x"],
        "B_w1": _B_in["w1"],
        "B_b1": _B_in["b1"],
        "B_w2": _B_in["w2"],
        "B_b2": _B_in["b2"],
    }

def reference(A_x, A_w_r, A_w_i, B_x, B_w1, B_b1, B_w2, B_b2):
    def _A_ref(x, w_r, w_i):
        B, S, D = x.shape
        X = (lambda x, axes=(-2,-1): torch.fft.rfft2(x.float(), dim=axes))(x, axes=(-2, -1))
        W = w_r + 1j * w_i
        X = X * W
        y = (lambda x, s, axes=(-2,-1): torch.fft.irfft2(x, s=s, dim=axes).to(torch.bfloat16))(X, (S, D), axes=(-2, -1))
        return y

    def _B_ref(x, w1, b1, w2, b2):
        y = _layernorm(x, axis=-1)
        h = _gelu(torch.einsum("bsd,df->bsf", y, w1) + b1)
        return torch.einsum("bsf,fd->bsd", h, w2) + b2

    x = A_x
    h = x + _A_ref(_layernorm(x, axis=-1), A_w_r, A_w_i)
    h2 = h + _B_ref(_layernorm(h, axis=-1), B_w1, B_b1, B_w2, B_b2)
    return h2
```

```asm
; @launch grid=(256,1,1) block=(256,1,1) lds=163840
.amdgcn_target "amdgcn-amd-amdhsa--gfx950"
.text
.globl sequential_preLN__spectral_gfnet__mixer_channel_mlp__prompt_kernel
.p2align 8
.type sequential_preLN__spectral_gfnet__mixer_channel_mlp__prompt_kernel,@function
sequential_preLN__spectral_gfnet__mixer_channel_mlp__prompt_kernel:

	s_cmp_ge_u32 s2, 0x100
	s_cbranch_scc1 sequential_preLN__spectral_gfnet__mixer_channel_mlp__prompt_kernel_end
	s_load_dwordx16 s[4:19], s[0:1], 0
	s_load_dwordx4 s[20:23], s[0:1], 64
	s_load_dwordx2 s[24:25], s[0:1], 0x50
	v_lshrrev_b32 v2, 6, v0
	s_nop 0
	v_readfirstlane_b32 s3, v2
	v_and_b32 v1, 63, v0
	s_and_b32 s60, s2, 7
	s_lshl_b32 s26, s60, 1
	s_lshr_b32 s60, s2, 7
	s_add_u32 s26, s26, s60
	s_bfe_u32 s27, s2, 0x40003
	v_and_b32 v4, 15, v1
	v_lshrrev_b32 v5, 4, v1
	s_and_b32 s60, s27, 7
	s_lshl_b32 s60, s60, 2
	s_add_u32 s60, s60, s3
	s_mul_i32 s69, s60, 0xe000
	s_getpc_b64 s[40:41]
sequential_preLN__spectral_gfnet__mixer_channel_mlp__prompt_kernel_spc:
	s_mov_b32 s42, sequential_preLN__spectral_gfnet__mixer_channel_mlp__prompt_kernel_end-sequential_preLN__spectral_gfnet__mixer_channel_mlp__prompt_kernel_spc
	s_mov_b32 s43, 0x20000
	s_lshr_b32 s60, s2, 3
	v_mul_u32_u24 v2, 32, v1
	v_add_u32 v2, s60, v2
	v_lshlrev_b32 v2, 7, v2
	v_mov_b32 v3, 0x10000000
	v_cmp_gt_u32 vcc, 10, v0
	s_nop 1
	v_cndmask_b32 v2, v3, v2, vcc
	buffer_load_dword v14, v2, s[40:43], 0 offen
	s_and_b32 s60, s26, 1
	s_cmp_lg_u32 s60, 0
	s_cbranch_scc0 sequential_preLN__spectral_gfnet__mixer_channel_mlp__prompt_kernel_helper
	s_and_b32 s60, s2, 7
	s_lshl_b32 s80, s60, 4
	s_add_u32 s80, s80, s27
	s_and_b32 s60, s80, 3
	s_lshl_b32 s60, s60, 4
	s_lshl_b32 s61, s3, 2
	s_add_u32 s60, s60, s61
	s_lshl_b32 s60, s60, 5
	s_lshr_b32 s61, s80, 2
	s_add_u32 s60, s60, s61
	s_lshl_b32 s81, s60, 10
	v_and_b32 v2, 3, v1
	v_lshlrev_b32 v24, 15, v2
	v_lshl_add_u32 v24, v5, 5, v24
	v_bfe_u32 v2, v1, 2, 2
	v_lshl_add_u32 v24, v2, 3, v24
	s_waitcnt lgkmcnt(0)
	s_mov_b32 s56, s4
	s_mov_b32 s57, s5
	s_mov_b32 s58, 0x200000
	s_mov_b32 s59, 0x20000
	buffer_load_dwordx2 v[26:27], v24, s[56:59], s81 offen
	buffer_load_dwordx2 v[28:29], v24, s[56:59], s81 offen offset:128
	buffer_load_dwordx2 v[30:31], v24, s[56:59], s81 offen offset:256
	buffer_load_dwordx2 v[32:33], v24, s[56:59], s81 offen offset:384
	buffer_load_dwordx2 v[34:35], v24, s[56:59], s81 offen offset:512
	buffer_load_dwordx2 v[36:37], v24, s[56:59], s81 offen offset:640
	buffer_load_dwordx2 v[38:39], v24, s[56:59], s81 offen offset:768
	buffer_load_dwordx2 v[40:41], v24, s[56:59], s81 offen offset:896
	s_mov_b32 s36, s22
	s_mov_b32 s37, s23
	s_mov_b32 s38, 0x100
	s_mov_b32 s39, 0x20000
	s_mov_b32 s52, s24
	s_mov_b32 s53, s25
	s_mov_b32 s54, 0x204000
	s_mov_b32 s55, 0x20000
	v_cvt_f32_u32 v24, v4
	v_cvt_f32_u32 v25, v5
	v_cmp_eq_u32 s[82:83], 0, v4
	v_cmp_gt_u32 s[84:85], 8, v4
	s_mov_b64 s[86:87], 0xffff
	v_mul_f32 v60, v24, v25
	v_mul_f32 v42, 0x3d000000, v60
	v_mul_f32 v43, 0x3e000000, v24
	v_cos_f32 v44, v42
	v_sin_f32 v52, v42
	v_add_f32 v42, v42, v43
	v_cos_f32 v45, v42
	v_sin_f32 v53, v42
	v_add_f32 v42, v42, v43
	v_cos_f32 v46, v42
	v_sin_f32 v54, v42
	v_add_f32 v42, v42, v43
	v_cos_f32 v47, v42
	v_sin_f32 v55, v42
	v_add_f32 v42, v42, v43
	v_cos_f32 v48, v42
	v_sin_f32 v56, v42
	v_add_f32 v42, v42, v43
	v_cos_f32 v49, v42
	v_sin_f32 v57, v42
	v_add_f32 v42, v42, v43
	v_cos_f32 v50, v42
	v_sin_f32 v58, v42
	v_add_f32 v42, v42, v43
	v_cos_f32 v51, v42
	v_sin_f32 v59, v42
	v_and_b32 v2, 1, v5
	v_mul_u32_u24 v2, 0x8000, v2
	v_lshl_or_b32 v2, v2, 16, v2
	v_or_b32 v2, 0x3f803f80, v2
	v_cvt_pk_bf16_f32 v62, v44, v45
	v_cvt_pk_bf16_f32 v66, -v52, -v53
	v_cndmask_b32 v66, v66, v2, s[82:83]
	v_cvt_pk_bf16_f32 v63, v46, v47
	v_cvt_pk_bf16_f32 v67, -v54, -v55
	v_cndmask_b32 v67, v67, v2, s[82:83]
	v_cvt_pk_bf16_f32 v64, v48, v49
	v_cvt_pk_bf16_f32 v68, -v56, -v57
	v_cndmask_b32 v68, v68, v2, s[82:83]
	v_cvt_pk_bf16_f32 v65, v50, v51
	v_cvt_pk_bf16_f32 v69, -v58, -v59
	v_cndmask_b32 v69, v69, v2, s[82:83]
	v_mul_f32 v42, 0x3c000000, v60
	v_mul_f32 v43, 0x3b000000, v24
	v_cos_f32 v70, v42
	v_sin_f32 v74, v42
	v_add_f32 v42, v42, v43
	v_cos_f32 v71, v42
	v_sin_f32 v75, v42
	v_add_f32 v42, v42, v43
	v_cos_f32 v72, v42
	v_sin_f32 v76, v42
	v_add_f32 v42, v42, v43
	v_cos_f32 v73, v42
	v_sin_f32 v77, v42
	v_mul_f32 v42, 0x3e800000, v60
	v_mul_f32 v43, 0x3d800000, v24
	v_cos_f32 v44, v42
	v_sin_f32 v52, v42
	v_add_f32 v42, v42, v43
	v_cos_f32 v45, v42
	v_sin_f32 v53, v42
	v_add_f32 v42, v42, v43
	v_cos_f32 v46, v42
	v_sin_f32 v54, v42
	v_add_f32 v42, v42, v43
	v_cos_f32 v47, v42
	v_sin_f32 v55, v42
	v_mov_b32 v3, 0x80008000
	v_cndmask_b32 v2, v3, 0, s[84:85]
	v_xor_b32 v3, v3, v2
	v_cvt_pk_bf16_f32 v78, v44, v45
	v_cvt_pk_bf16_f32 v80, v52, v53
	v_xor_b32 v82, v80, v3
	v_xor_b32 v84, v78, v2
	v_cvt_pk_bf16_f32 v79, v46, v47
	v_cvt_pk_bf16_f32 v81, v54, v55
	v_xor_b32 v83, v81, v3
	v_xor_b32 v85, v79, v2
	v_add_f32 v2, v24, v24
	v_add_f32 v3, 0xc1700000, v2
	v_cndmask_b32 v2, v3, v2, s[84:85]
	v_mul_f32 v43, 0x3d000000, v2
	v_mul_f32 v42, v25, v43
	v_mul_f32 v42, 4.0, v42
	v_cos_f32 v44, v42
	v_sin_f32 v52, v42
	v_add_f32 v42, v42, v43
	v_cos_f32 v45, v42
	v_sin_f32 v53, v42
	v_add_f32 v42, v42, v43
	v_cos_f32 v46, v42
	v_sin_f32 v54, v42
	v_add_f32 v42, v42, v43
	v_cos_f32 v47, v42
	v_sin_f32 v55, v42
	v_mov_b32 v3, 0xbf803f80
	v_cvt_pk_bf16_f32 v2, v44, v45
	v_cndmask_b32 v86, 0, v2, s[84:85]
	v_cndmask_b32 v88, v2, 0, s[84:85]
	v_cvt_pk_bf16_f32 v2, -v52, -v53
	v_cndmask_b32 v2, v2, v3, s[82:83]
	v_cndmask_b32 v90, 0, v2, s[84:85]
	v_cndmask_b32 v92, v2, 0, s[84:85]
	v_cvt_pk_bf16_f32 v2, v46, v47
	v_cndmask_b32 v87, 0, v2, s[84:85]
	v_cndmask_b32 v89, v2, 0, s[84:85]
	v_cvt_pk_bf16_f32 v2, -v54, -v55
	v_cndmask_b32 v2, v2, v3, s[82:83]
	v_cndmask_b32 v91, 0, v2, s[84:85]
	v_cndmask_b32 v93, v2, 0, s[84:85]
	s_mul_i32 s60, s3, 0x1040
	s_add_u32 s60, s60, 0x20000
	v_lshl_add_u32 v3, v5, 8, s60
	v_add_u32 v2, 0, v4
	v_and_b32 v2, 15, v2
	v_lshl_add_u32 v94, v2, 4, v3
	v_add_u32 v2, 1, v4
	v_and_b32 v2, 15, v2
	v_lshl_add_u32 v95, v2, 4, v3
	v_add_u32 v95, 0x400, v95
	v_add_u32 v2, 2, v4
	v_and_b32 v2, 15, v2
	v_lshl_add_u32 v96, v2, 4, v3
	v_add_u32 v96, 0x800, v96
	v_add_u32 v2, 3, v4
	v_and_b32 v2, 15, v2
	v_lshl_add_u32 v97, v2, 4, v3
	v_add_u32 v97, 0xc00, v97
	v_lshrrev_b32 v61, 2, v1
	v_sub_u32 v102, 16, v61
	v_and_b32 v102, 15, v102
	v_and_b32 v2, 3, v1
	v_mul_u32_u24 v3, 0x1040, v2
	v_add_u32 v3, 0x20000, v3
	v_and_b32 v106, 3, v61
	v_lshl_add_u32 v104, v106, 10, v3
	v_lshrrev_b32 v2, 2, v61
	v_lshl_add_u32 v104, v2, 8, v104
	v_and_b32 v107, 3, v102
	v_lshl_add_u32 v105, v107, 10, v3
	v_lshrrev_b32 v2, 2, v102
	v_lshl_add_u32 v105, v2, 8, v105
	v_cmp_eq_u32 vcc, 0, v61
	s_lshl_b32 s60, s3, 1
	v_add_u32 v2, s60, v106
	v_and_b32 v2, 15, v2
	v_lshl_add_u32 v98, v2, 4, v104
	s_lshl_b32 s60, s3, 1
	s_sub_u32 s61, 15, s60
	s_add_u32 s60, s60, 8
	v_mov_b32 v103, s61
	v_mov_b32 v2, s60
	v_cndmask_b32 v103, v103, v2, vcc
	v_add_u32 v2, v103, v107
	v_and_b32 v2, 15, v2
	v_lshl_add_u32 v99, v2, 4, v105
	s_lshl_b32 s60, s3, 1
	s_add_u32 s60, s60, 1
	v_add_u32 v2, s60, v106
	v_and_b32 v2, 15, v2
	v_lshl_add_u32 v100, v2, 4, v104
	s_lshl_b32 s60, s3, 1
	s_add_u32 s60, s60, 1
	s_sub_u32 s61, 15, s60
	s_add_u32 s60, s60, 8
	v_mov_b32 v103, s61
	v_mov_b32 v2, s60
	v_cndmask_b32 v103, v103, v2, vcc
	v_add_u32 v2, v103, v107
	v_and_b32 v2, 15, v2
	v_lshl_add_u32 v101, v2, 4, v105
	v_lshrrev_b32 v2, 3, v1
	v_and_b32 v3, 7, v1
	v_lshlrev_b32 v3, 4, v3
	v_lshl_add_u32 v108, v2, 14, v3
	s_lshl_b32 s81, s3, 19
	s_lshl_b32 s60, s80, 7
	s_add_u32 s81, s81, s60
	s_lshr_b32 s60, s2, 7
	s_mul_i32 s60, s60, 14
	s_add_u32 s60, s60, s27
	s_mul_i32 s77, s60, 37
	s_lshr_b32 s77, s77, 8
	s_mul_i32 s61, s77, 7
	s_sub_u32 s78, s60, s61
	s_and_b32 s60, s2, 1
	s_mul_i32 s60, s60, 7
	s_add_u32 s78, s78, s60
	s_bfe_u32 s60, s2, 0x20001
	s_lshl_b32 s60, s60, 2
	s_add_u32 s77, s77, s60
	v_mov_b32 v9, 1
	v_lshlrev_b32 v6, 4, v1
	v_lshrrev_b32 v2, 4, v1
	v_mul_u32_u24 v11, 0xe00, v2
	v_lshlrev_b32 v2, 2, v2
	v_and_b32 v3, 15, v1
	v_xor_b32 v2, v2, v3
	v_lshl_add_u32 v11, v2, 4, v11
	s_lshl_b32 s60, s3, 7
	v_xor_b32 v12, s60, v6
	s_lshr_b32 s70, s27, 3
	s_mul_i32 s63, s3, 0x3800
	s_lshl_b32 s60, s78, 8
	s_add_u32 s63, s63, s60
	s_lshl_b32 s68, s3, 10
	s_lshl_b32 s79, s77, 4
	s_add_u32 s79, s79, s78
	s_lshl_b32 s79, s79, 7
	v_mov_b32 v2, 0x10000000
	v_cmp_gt_u32 vcc, 16, v1
	v_lshlrev_b32 v3, 7, v1
	s_nop 0
	v_cndmask_b32 v8, v2, v3, vcc
	v_cmp_gt_u32 vcc, 8, v1
	v_lshlrev_b32 v3, 9, v1
	s_nop 0
	v_cndmask_b32 v7, v2, v3, vcc
	v_lshrrev_b32 v2, 5, v1
	v_lshlrev_b32 v10, 3, v2
	s_lshl_b32 s71, s26, 4
	s_add_u32 s71, s71, s27
	s_lshl_b32 s71, s71, 7
	s_lshl_b32 s72, s26, 2
	s_lshl_b32 s60, s70, 1
	s_add_u32 s72, s72, s60
	s_lshl_b32 s60, s72, 2
	s_add_u32 s60, s60, s3
	s_lshl_b32 s60, s60, 1
	s_add_u32 s60, s60, s70
	s_mul_i32 s74, s60, 0x3800
	s_xor_b32 s61, s70, 1
	s_lshl_b32 s60, s72, 2
	s_add_u32 s60, s60, s3
	s_lshl_b32 s60, s60, 1
	s_add_u32 s60, s60, s61
	s_mul_i32 s75, s60, 0x3800
	s_lshl_b32 s73, s71, 2
	s_lshl_b32 s60, s3, 7
	s_add_u32 s73, s73, s60
	s_add_u32 s73, s73, 0x8000
	s_add_u32 s28, s24, 0x1490000
	s_addc_u32 s29, s25, 0
	s_mov_b32 s30, 0x38000
	s_mov_b32 s31, 0x20000
	s_add_u32 s32, s24, 0xbd0000
	s_addc_u32 s33, s25, 0
	s_mov_b32 s34, 0x1c0000
	s_mov_b32 s35, 0x20000
	s_mov_b32 s44, s12
	s_mov_b32 s45, s13
	s_mov_b32 s46, 0x1c0000
	s_mov_b32 s47, 0x20000
	s_cmp_ge_u32 s27, 14
	s_cselect_b32 s46, 0, 0x1c0000
	s_and_b32 s60, s77, 1
	s_mul_i32 s61, s60, 0xe0000
	s_add_u32 s63, s63, s61
	s_lshl_b32 s61, s60, 16
	s_add_u32 s68, s68, s61
	s_mul_i32 s23, s60, 0x1c0000
	s_mov_b32 s10, s14
	s_mov_b32 s11, s15
	s_mov_b32 s6, s28
	s_mov_b32 s7, s29
	s_mul_i32 s60, s70, 0x7000
	s_add_u32 s8, s69, s60
	s_xor_b32 s60, s70, 1
	s_mul_i32 s60, s60, 0x7000
	s_add_u32 s9, s69, s60
	s_waitcnt vmcnt(0)
	v_mov_b32 v44, 0x3f803f80
	v_dot2_f32_bf16 v24, v26, v44, 0
	v_dot2_f32_bf16 v25, v26, v26, 0
	v_dot2_f32_bf16 v42, v27, v44, 0
	v_dot2_f32_bf16 v43, v27, v27, 0
	v_dot2_f32_bf16 v24, v28, v44, v24
	v_dot2_f32_bf16 v25, v28, v28, v25
	v_dot2_f32_bf16 v42, v29, v44, v42
	v_dot2_f32_bf16 v43, v29, v29, v43
	v_dot2_f32_bf16 v24, v30, v44, v24
	v_dot2_f32_bf16 v25, v30, v30, v25
	v_dot2_f32_bf16 v42, v31, v44, v42
	v_dot2_f32_bf16 v43, v31, v31, v43
	v_dot2_f32_bf16 v24, v32, v44, v24
	v_dot2_f32_bf16 v25, v32, v32, v25
	v_dot2_f32_bf16 v42, v33, v44, v42
	v_dot2_f32_bf16 v43, v33, v33, v43
	v_dot2_f32_bf16 v24, v34, v44, v24
	v_dot2_f32_bf16 v25, v34, v34, v25
	v_dot2_f32_bf16 v42, v35, v44, v42
	v_dot2_f32_bf16 v43, v35, v35, v43
	v_dot2_f32_bf16 v24, v36, v44, v24
	v_dot2_f32_bf16 v25, v36, v36, v25
	v_dot2_f32_bf16 v42, v37, v44, v42
	v_dot2_f32_bf16 v43, v37, v37, v43
	v_dot2_f32_bf16 v24, v38, v44, v24
	v_dot2_f32_bf16 v25, v38, v38, v25
	v_dot2_f32_bf16 v42, v39, v44, v42
	v_dot2_f32_bf16 v43, v39, v39, v43
	v_dot2_f32_bf16 v24, v40, v44, v24
	v_dot2_f32_bf16 v25, v40, v40, v25
	v_dot2_f32_bf16 v42, v41, v44, v42
	v_dot2_f32_bf16 v43, v41, v41, v43
	s_nop 2
	v_add_f32 v24, v24, v42
	v_add_f32 v25, v25, v43
	s_nop 1
	v_permlane32_swap_b32 v24, v25
	v_add_f32 v24, v24, v25
	v_lshlrev_b32 v110, 16, v26
	v_and_b32 v111, 0xffff0000, v26
	v_add_f32_dpp v24, v24, v24 row_ror:4 row_mask:0xf bank_mask:0xf
	v_lshlrev_b32 v112, 16, v27
	v_and_b32 v113, 0xffff0000, v27
	v_add_f32_dpp v24, v24, v24 row_ror:8 row_mask:0xf bank_mask:0xf
	v_mov_b32 v42, v24
	v_lshlrev_b32 v114, 16, v28
	v_and_b32 v115, 0xffff0000, v28
	v_permlane16_swap_b32 v24, v42
	v_add_f32 v24, v24, v42
	v_mov_b32 v25, v24
	v_lshlrev_b32 v116, 16, v29
	v_and_b32 v117, 0xffff0000, v29
	v_permlane32_swap_b32 v24, v25
	v_mul_f32 v24, 0x3b000000, v24
	v_lshlrev_b32 v118, 16, v30
	v_and_b32 v119, 0xffff0000, v30
	v_mul_f32 v25, 0x3b000000, v25
	v_lshlrev_b32 v120, 16, v31
	v_and_b32 v121, 0xffff0000, v31
	v_fma_f32 v25, -v24, v24, v25
	v_lshlrev_b32 v122, 16, v32
	v_and_b32 v123, 0xffff0000, v32
	v_max_f32 v25, 0, v25
	v_lshlrev_b32 v124, 16, v33
	v_and_b32 v125, 0xffff0000, v33
	v_cvt_pk_bf16_f32 v24, v24, v24
	v_lshlrev_b32 v24, 16, v24
	v_lshlrev_b32 v126, 16, v34
	v_and_b32 v127, 0xffff0000, v34
	v_cvt_pk_bf16_f32 v25, v25, v25
	v_lshlrev_b32 v25, 16, v25
	v_lshlrev_b32 v128, 16, v35
	v_and_b32 v129, 0xffff0000, v35
	v_add_f32 v25, 0x3727c5ac, v25
	v_lshlrev_b32 v130, 16, v36
	v_and_b32 v131, 0xffff0000, v36
	v_cvt_pk_bf16_f32 v25, v25, v25
	v_lshlrev_b32 v25, 16, v25
	v_lshlrev_b32 v132, 16, v37
	v_and_b32 v133, 0xffff0000, v37
	v_sqrt_f32 v25, v25
	v_lshlrev_b32 v134, 16, v38
	v_and_b32 v135, 0xffff0000, v38
	v_cvt_pk_bf16_f32 v25, v25, v25
	v_lshlrev_b32 v25, 16, v25
	v_lshlrev_b32 v136, 16, v39
	v_and_b32 v137, 0xffff0000, v39
	v_rcp_f32 v25, v25
	v_lshlrev_b32 v138, 16, v40
	v_and_b32 v139, 0xffff0000, v40
	v_mul_f32 v24, v24, v25
	v_lshlrev_b32 v140, 16, v41
	v_and_b32 v141, 0xffff0000, v41
	v_fma_f32 v110, v110, v25, -v24
	v_fma_f32 v111, v111, v25, -v24
	v_fma_f32 v112, v112, v25, -v24
	v_fma_f32 v113, v113, v25, -v24
	v_fma_f32 v114, v114, v25, -v24
	v_fma_f32 v115, v115, v25, -v24
	v_fma_f32 v116, v116, v25, -v24
	v_fma_f32 v117, v117, v25, -v24
	v_fma_f32 v118, v118, v25, -v24
	v_fma_f32 v119, v119, v25, -v24
	v_fma_f32 v120, v120, v25, -v24
	v_fma_f32 v121, v121, v25, -v24
	v_fma_f32 v122, v122, v25, -v24
	v_fma_f32 v123, v123, v25, -v24
	v_fma_f32 v124, v124, v25, -v24
	v_fma_f32 v125, v125, v25, -v24
	v_fma_f32 v126, v126, v25, -v24
	v_fma_f32 v127, v127, v25, -v24
	v_fma_f32 v128, v128, v25, -v24
	v_fma_f32 v129, v129, v25, -v24
	v_fma_f32 v130, v130, v25, -v24
	v_fma_f32 v131, v131, v25, -v24
	v_fma_f32 v132, v132, v25, -v24
	v_fma_f32 v133, v133, v25, -v24
	v_fma_f32 v134, v134, v25, -v24
	v_fma_f32 v135, v135, v25, -v24
	v_fma_f32 v136, v136, v25, -v24
	v_fma_f32 v137, v137, v25, -v24
	v_fma_f32 v138, v138, v25, -v24
	v_fma_f32 v139, v139, v25, -v24
	v_fma_f32 v140, v140, v25, -v24
	v_fma_f32 v141, v141, v25, -v24
	v_cvt_pk_bf16_f32 v26, v110, v114
	v_cvt_pk_bf16_f32 v27, v118, v122
	v_cvt_pk_bf16_f32 v28, v126, v130
	v_cvt_pk_bf16_f32 v29, v134, v138
	s_nop 1
	v_mfma_f32_16x16x32_bf16 v[142:145], v[26:29], v[62:65], 0
	v_mfma_f32_16x16x32_bf16 v[146:149], v[26:29], v[66:69], 0
	v_cvt_pk_bf16_f32 v30, v111, v115
	v_cvt_pk_bf16_f32 v31, v119, v123
	v_cvt_pk_bf16_f32 v32, v127, v131
	v_cvt_pk_bf16_f32 v33, v135, v139
	s_nop 1
	v_mfma_f32_16x16x32_bf16 v[150:153], v[30:33], v[62:65], 0
	v_mfma_f32_16x16x32_bf16 v[154:157], v[30:33], v[66:69], 0
	v_cvt_pk_bf16_f32 v34, v112, v116
	v_cvt_pk_bf16_f32 v35, v120, v124
	v_cvt_pk_bf16_f32 v36, v128, v132
	v_cvt_pk_bf16_f32 v37, v136, v140
	s_nop 1
	v_mfma_f32_16x16x32_bf16 v[158:161], v[34:37], v[62:65], 0
	v_mfma_f32_16x16x32_bf16 v[162:165], v[34:37], v[66:69], 0
	v_cvt_pk_bf16_f32 v38, v113, v117
	v_cvt_pk_bf16_f32 v39, v121, v125
	v_cvt_pk_bf16_f32 v40, v129, v133
	v_cvt_pk_bf16_f32 v41, v137, v141
	s_nop 1
	v_mfma_f32_16x16x32_bf16 v[166:169], v[38:41], v[62:65], 0
	v_mfma_f32_16x16x32_bf16 v[170:173], v[38:41], v[66:69], 0
	v_mul_f32 v110, v142, v70
	v_mul_f32 v114, v146, v70
	v_fmac_f32 v110, v146, v74
	v_fma_f32 v114, -v142, v74, v114
	v_mul_f32 v111, v150, v71
	v_mul_f32 v115, v154, v71
	v_fmac_f32 v111, v154, v75
	v_fma_f32 v115, -v150, v75, v115
	v_mul_f32 v112, v158, v72
	v_mul_f32 v116, v162, v72
	v_fmac_f32 v112, v162, v76
	v_fma_f32 v116, -v158, v76, v116
	v_mul_f32 v113, v166, v73
	v_mul_f32 v117, v170, v73
	v_fmac_f32 v113, v170, v77
	v_fma_f32 v117, -v166, v77, v117
	v_cvt_pk_bf16_f32 v118, v110, v111
	v_cvt_pk_bf16_f32 v119, v112, v113
	v_cvt_pk_bf16_f32 v120, v114, v115
	v_cvt_pk_bf16_f32 v121, v116, v117
	s_nop 1
	v_mfma_f32_16x16x32_bf16 v[182:185], v[118:121], v[86:89], 0
	v_mfma_f32_16x16x32_bf16 v[186:189], v[118:121], v[90:93], 0
	v_mfma_f32_16x16x32_bf16 v[174:177], v[118:121], v[78:81], 0
	v_mfma_f32_16x16x32_bf16 v[178:181], v[118:121], v[82:85], 0
	v_mul_f32 v110, v143, v70
	v_mul_f32 v114, v147, v70
	v_fmac_f32 v110, v147, v74
	v_fma_f32 v114, -v143, v74, v114
	v_mul_f32 v111, v151, v71
	v_mul_f32 v115, v155, v71
	v_fmac_f32 v111, v155, v75
	v_fma_f32 v115, -v151, v75, v115
	v_mul_f32 v112, v159, v72
	v_mul_f32 v116, v163, v72
	v_fmac_f32 v112, v163, v76
	v_fma_f32 v116, -v159, v76, v116
	v_mul_f32 v113, v167, v73
	v_mul_f32 v117, v171, v73
	v_fmac_f32 v113, v171, v77
	v_fma_f32 v117, -v167, v77, v117
	v_cvt_pk_bf16_f32 v122, v110, v111
	v_cvt_pk_bf16_f32 v123, v112, v113
	v_cvt_pk_bf16_f32 v124, v114, v115
	v_cvt_pk_bf16_f32 v125, v116, v117
	s_nop 1
	v_mfma_f32_16x16x32_bf16 v[198:201], v[122:125], v[86:89], 0
	v_mfma_f32_16x16x32_bf16 v[202:205], v[122:125], v[90:93], 0
	v_mfma_f32_16x16x32_bf16 v[190:193], v[122:125], v[78:81], 0
	v_mfma_f32_16x16x32_bf16 v[194:197], v[122:125], v[82:85], 0
	v_mul_f32 v110, v144, v70
	v_mul_f32 v114, v148, v70
	v_fmac_f32 v110, v148, v74
	v_fma_f32 v114, -v144, v74, v114
	v_mul_f32 v111, v152, v71
	v_mul_f32 v115, v156, v71
	v_fmac_f32 v111, v156, v75
	v_fma_f32 v115, -v152, v75, v115
	v_mul_f32 v112, v160, v72
	v_mul_f32 v116, v164, v72
	v_fmac_f32 v112, v164, v76
	v_fma_f32 v116, -v160, v76, v116
	v_mul_f32 v113, v168, v73
	v_mul_f32 v117, v172, v73
	v_fmac_f32 v113, v172, v77
	v_fma_f32 v117, -v168, v77, v117
	v_cvt_pk_bf16_f32 v126, v110, v111
	v_cvt_pk_bf16_f32 v127, v112, v113
	v_cvt_pk_bf16_f32 v128, v114, v115
	v_cvt_pk_bf16_f32 v129, v116, v117
	s_nop 1
	v_mfma_f32_16x16x32_bf16 v[214:217], v[126:129], v[86:89], 0
	v_mfma_f32_16x16x32_bf16 v[218:221], v[126:129], v[90:93], 0
	v_mfma_f32_16x16x32_bf16 v[206:209], v[126:129], v[78:81], 0
	v_mfma_f32_16x16x32_bf16 v[210:213], v[126:129], v[82:85], 0
	v_mul_f32 v110, v145, v70
	v_mul_f32 v114, v149, v70
	v_fmac_f32 v110, v149, v74
	v_fma_f32 v114, -v145, v74, v114
	v_mul_f32 v111, v153, v71
	v_mul_f32 v115, v157, v71
	v_fmac_f32 v111, v157, v75
	v_fma_f32 v115, -v153, v75, v115
	v_mul_f32 v112, v161, v72
	v_mul_f32 v116, v165, v72
	v_fmac_f32 v112, v165, v76
	v_fma_f32 v116, -v161, v76, v116
	v_mul_f32 v113, v169, v73
	v_mul_f32 v117, v173, v73
	v_fmac_f32 v113, v173, v77
	v_fma_f32 v117, -v169, v77, v117
	v_cvt_pk_bf16_f32 v130, v110, v111
	v_cvt_pk_bf16_f32 v131, v112, v113
	v_cvt_pk_bf16_f32 v132, v114, v115
	v_cvt_pk_bf16_f32 v133, v116, v117
	s_nop 1
	v_mfma_f32_16x16x32_bf16 v[230:233], v[130:133], v[86:89], 0
	v_mfma_f32_16x16x32_bf16 v[234:237], v[130:133], v[90:93], 0
	v_mfma_f32_16x16x32_bf16 v[222:225], v[130:133], v[78:81], 0
	v_mfma_f32_16x16x32_bf16 v[226:229], v[130:133], v[82:85], 0
	v_cvt_pk_bf16_f32 v146, v175, v191
	v_cvt_pk_bf16_f32 v147, v179, v195
	s_nop 4
	v_cvt_pk_bf16_f32 v148, v207, v223
	v_cvt_pk_bf16_f32 v149, v211, v227
	ds_write_b128 v95, v[146:149]
	v_cvt_pk_bf16_f32 v150, v176, v192
	v_cvt_pk_bf16_f32 v151, v180, v196
	v_cvt_pk_bf16_f32 v152, v208, v224
	v_cvt_pk_bf16_f32 v153, v212, v228
	ds_write_b128 v96, v[150:153]
	v_cvt_pk_bf16_f32 v154, v177, v193
	v_cvt_pk_bf16_f32 v155, v181, v197
	v_cvt_pk_bf16_f32 v156, v209, v225
	v_cvt_pk_bf16_f32 v157, v213, v229
	ds_write_b128 v97, v[154:157]
	v_cndmask_b32 v174, v174, v182, s[86:87]
	v_cndmask_b32 v178, v178, v186, s[86:87]
	v_cndmask_b32 v190, v190, v198, s[86:87]
	v_cndmask_b32 v194, v194, v202, s[86:87]
	v_cndmask_b32 v206, v206, v214, s[86:87]
	v_cndmask_b32 v210, v210, v218, s[86:87]
	v_cndmask_b32 v222, v222, v230, s[86:87]
	v_cndmask_b32 v226, v226, v234, s[86:87]
	v_cvt_pk_bf16_f32 v142, v174, v190
	v_cvt_pk_bf16_f32 v143, v178, v194
	v_cvt_pk_bf16_f32 v144, v206, v222
	v_cvt_pk_bf16_f32 v145, v210, v226
	ds_write_b128 v94, v[142:145]
	s_waitcnt lgkmcnt(0)
	s_barrier
	v_mov_b32 v15, 0
	buffer_load_dword v14, v15, s[36:39], 0 offen offset:128 sc1
	ds_read_b128 v[158:161], v98
	ds_read_b128 v[162:165], v99
	ds_read_b128 v[166:169], v100
	ds_read_b128 v[170:173], v101
	s_waitcnt lgkmcnt(3)
	buffer_store_dwordx4 v[158:161], v108, s[52:55], s81 offen sc1
	s_add_u32 s60, s81, 0x20000
	s_waitcnt lgkmcnt(2)
	buffer_store_dwordx4 v[162:165], v108, s[52:55], s60 offen sc1
	s_add_u32 s60, s81, 0x40000
	s_waitcnt lgkmcnt(1)
	buffer_store_dwordx4 v[166:169], v108, s[52:55], s60 offen sc1
	s_add_u32 s60, s81, 0x60000
	s_waitcnt lgkmcnt(0)
	buffer_store_dwordx4 v[170:173], v108, s[52:55], s60 offen sc1
	v_mov_b32 v134, v158
	v_mov_b32 v135, 0
	v_mov_b32 v136, v160
	v_mov_b32 v137, 0
	v_mov_b32 v138, v159
	v_mov_b32 v139, 0
	v_mov_b32 v140, v161
	v_mov_b32 v141, 0
	s_cmp_eq_u32 s3, 0
	s_cselect_b32 s60, 4, 0
	v_mov_b32 v3, 0x10000000
	v_cmp_gt_u32 vcc, s60, v1
	s_nop 1
	v_cndmask_b32 v2, v3, v108, vcc
	s_add_u32 s60, s81, 0x200000
	buffer_store_dwordx4 v[134:137], v2, s[52:55], s60 offen sc1
	buffer_store_dwordx4 v[138:141], v2, s[52:55], s60 offen offset:64 sc1
sequential_preLN__spectral_gfnet__mixer_channel_mlp__prompt_kernel_bent:
	s_nop 1
	s_and_b32 s60, s2, 7
	s_lshl_b32 s60, s60, 4
	s_add_u32 s60, s60, s27
	s_cmp_eq_u32 s2, 0x78
	s_cselect_b32 s80, 0x80, s60
	v_cvt_f32_u32 v24, v4
	v_cvt_f32_u32 v25, v5
	v_mul_f32 v25, 4.0, v25
	s_lshl_b32 s60, s3, 4
	v_add_u32 v2, s60, v4
	v_cvt_f32_u32 v26, v2
	v_cvt_f32_u32 v38, s60
	v_add_f32 v38, v38, v25
	v_and_b32 v29, 1, v4
	v_mul_u32_u24 v29, 0x8000, v29
	v_lshl_or_b32 v29, v29, 16, v29
	v_mul_f32 v28, 0x3c800000, v26
	v_add_f32 v27, 0, v25
	v_mul_f32 v27, v27, v28
	v_cos_f32 v30, v27
	v_sin_f32 v34, v27
	v_add_f32 v27, v27, v28
	v_cos_f32 v31, v27
	v_sin_f32 v35, v27
	v_add_f32 v27, v27, v28
	v_cos_f32 v32, v27
	v_sin_f32 v36, v27
	v_add_f32 v27, v27, v28
	v_cos_f32 v33, v27
	v_sin_f32 v37, v27
	v_cvt_pk_bf16_f32 v40, v30, v31
	v_cvt_pk_bf16_f32 v41, v34, v35
	v_cvt_pk_bf16_f32 v42, v32, v33
	v_cvt_pk_bf16_f32 v43, v36, v37
	v_xor_b32 v44, 0x80008000, v41
	v_mov_b32 v45, v40
	v_xor_b32 v46, 0x80008000, v43
	v_mov_b32 v47, v42
	v_add_f32 v27, 0x41800000, v25
	v_mul_f32 v27, v27, v28
	v_cos_f32 v30, v27
	v_sin_f32 v34, v27
	v_add_f32 v27, v27, v28
	v_cos_f32 v31, v27
	v_sin_f32 v35, v27
	v_add_f32 v27, v27, v28
	v_cos_f32 v32, v27
	v_sin_f32 v36, v27
	v_add_f32 v27, v27, v28
	v_cos_f32 v33, v27
	v_sin_f32 v37, v27
	v_cvt_pk_bf16_f32 v48, v30, v31
	v_cvt_pk_bf16_f32 v49, v34, v35
	v_cvt_pk_bf16_f32 v50, v32, v33
	v_cvt_pk_bf16_f32 v51, v36, v37
	v_xor_b32 v52, 0x80008000, v49
	v_mov_b32 v53, v48
	v_xor_b32 v54, 0x80008000, v51
	v_mov_b32 v55, v50
	v_xor_b32 v56, v40, v29
	v_xor_b32 v57, v41, v29
	v_xor_b32 v58, v42, v29
	v_xor_b32 v59, v43, v29
	v_xor_b32 v60, v44, v29
	v_xor_b32 v61, v45, v29
	v_xor_b32 v62, v46, v29
	v_xor_b32 v63, v47, v29
	v_xor_b32 v64, v48, v29
	v_xor_b32 v65, v49, v29
	v_xor_b32 v66, v50, v29
	v_xor_b32 v67, v51, v29
	v_xor_b32 v68, v52, v29
	v_xor_b32 v69, v53, v29
	v_xor_b32 v70, v54, v29
	v_xor_b32 v71, v55, v29
	v_mul_f32 v28, 0x3a000000, v26
	v_add_f32 v27, 0, v25
	v_mul_f32 v27, v27, v28
	v_cos_f32 v104, v27
	v_sin_f32 v112, v27
	v_add_f32 v27, v27, v28
	v_cos_f32 v105, v27
	v_sin_f32 v113, v27
	v_add_f32 v27, v27, v28
	v_cos_f32 v106, v27
	v_sin_f32 v114, v27
	v_add_f32 v27, v27, v28
	v_cos_f32 v107, v27
	v_sin_f32 v115, v27
	v_add_f32 v27, 0x41800000, v25
	v_mul_f32 v27, v27, v28
	v_cos_f32 v108, v27
	v_sin_f32 v116, v27
	v_add_f32 v27, v27, v28
	v_cos_f32 v109, v27
	v_sin_f32 v117, v27
	v_add_f32 v27, v27, v28
	v_cos_f32 v110, v27
	v_sin_f32 v118, v27
	v_add_f32 v27, v27, v28
	v_cos_f32 v111, v27
	v_sin_f32 v119, v27
	s_waitcnt vmcnt(0)
	v_readfirstlane_b32 s60, v14
	s_nop 1
	s_cmp_ge_u32 s60, 1
	s_cbranch_scc1 sequential_preLN__spectral_gfnet__mixer_channel_mlp__prompt_kernel_zokf
	s_mov_b32 s62, 0x80000
sequential_preLN__spectral_gfnet__mixer_channel_mlp__prompt_kernel_zpf:
	v_mov_b32 v15, 0
	buffer_load_dword v14, v15, s[36:39], 0 offen offset:128 sc1
	s_waitcnt vmcnt(0)
	v_readfirstlane_b32 s60, v14
	s_nop 1
	s_cmp_ge_u32 s60, 1
	s_cbranch_scc1 sequential_preLN__spectral_gfnet__mixer_channel_mlp__prompt_kernel_zokf
	s_sub_u32 s62, s62, 1
	s_cmp_lg_u32 s62, 0
	s_cbranch_scc1 sequential_preLN__spectral_gfnet__mixer_channel_mlp__prompt_kernel_zpf
sequential_preLN__spectral_gfnet__mixer_channel_mlp__prompt_kernel_zokf:
	s_barrier
	s_cmp_lg_u32 s3, 0
	s_cbranch_scc1 sequential_preLN__spectral_gfnet__mixer_channel_mlp__prompt_kernel_na1f
	v_lshlrev_b32 v2, 10, v1
	v_mov_b32 v3, 0x10000000
	v_cmp_gt_u32 vcc, 32, v1
	s_nop 1
	v_cndmask_b32 v2, v3, v2, vcc
	s_and_b32 s60, s2, 7
	s_lshl_b32 s60, s60, 7
	s_add_u32 s60, s60, 0x30000
	buffer_atomic_add v9, v2, s[28:31], s60 offen sc1
sequential_preLN__spectral_gfnet__mixer_channel_mlp__prompt_kernel_na1f:
	v_lshrrev_b32 v2, 1, v4
	v_xor_b32 v2, v2, v5
	v_lshlrev_b32 v2, 4, v2
	v_lshl_add_u32 v136, v4, 7, v2
	v_xor_b32 v137, 64, v136
	v_lshlrev_b32 v138, 4, v1
	s_lshl_b32 s60, s3, 10
	v_add_u32 v39, s60, v138
	v_add_u32 v136, 0x20000, v136
	v_add_u32 v137, 0x20000, v137
	v_add_u32 v138, 0x20000, v138
	s_add_u32 m0, s68, 0
	s_nop 0
	buffer_load_dwordx4 v11, s[44:47], s63 offen lds
	s_add_u32 s63, s63, 0xe000
	v_add_u32 v39, 0x20000, v39
	v_lshlrev_b32 v139, 16, v4
	v_lshl_add_u32 v139, v5, 4, v139
	s_and_b32 s60, s80, 0x7f
	s_lshl_b32 s60, s60, 7
	s_lshl_b32 s82, s3, 14
	s_add_u32 s82, s82, s60
	s_add_u32 s83, s82, 0x100000
	s_add_u32 s84, s82, 0x80000
	s_add_u32 s85, s83, 0x80000
	v_and_b32 v2, 7, v4
	v_lshlrev_b32 v141, 16, v2
	v_lshl_add_u32 v141, v5, 4, v141
	v_lshrrev_b32 v2, 3, v4
	v_lshl_add_u32 v141, v2, 6, v141
	s_cmp_eq_u32 s80, 0
	s_cselect_b32 s60, 0x10000000, 0
	v_mov_b32 v3, s60
	v_cmp_eq_u32 vcc, 0, v2
	s_add_u32 m0, s68, 0x1000
	s_nop 0
	buffer_load_dwordx4 v11, s[44:47], s63 offen lds
	s_add_u32 s63, s63, 0xe000
	v_cndmask_b32 v3, 0, v3, vcc
	v_or_b32 v141, v3, v141
	s_cmp_eq_u32 s80, 0
	s_cselect_b32 s60, 0x10000000, 0
	v_or_b32 v140, s60, v139
	v_mul_f32 v28, 0x3d000000, v24
	v_mul_f32 v27, v25, v28
	v_cos_f32 v30, v27
	v_sin_f32 v34, v27
	v_add_f32 v27, v27, v28
	v_cos_f32 v31, v27
	v_sin_f32 v35, v27
	s_add_u32 m0, s68, 0x2000
	s_nop 0
	buffer_load_dwordx4 v11, s[44:47], s63 offen lds
	s_add_u32 s63, s63, 0xe000
	v_add_f32 v27, v27, v28
	v_cos_f32 v32, v27
	v_sin_f32 v36, v27
	v_add_f32 v27, v27, v28
	v_cos_f32 v33, v27
	v_sin_f32 v37, v27
	v_cvt_pk_bf16_f32 v72, v30, v31
	v_cvt_pk_bf16_f32 v73, v34, v35
	v_cvt_pk_bf16_f32 v74, v32, v33
	v_cvt_pk_bf16_f32 v75, v36, v37
	s_add_u32 m0, s68, 0x3000
	s_nop 0
	buffer_load_dwordx4 v11, s[44:47], s63 offen lds
	s_add_u32 s63, s63, 0xe000
	v_xor_b32 v76, 0x80008000, v73
	v_mov_b32 v77, v72
	v_xor_b32 v78, 0x80008000, v75
	v_mov_b32 v79, v74
	v_xor_b32 v80, v72, v29
	v_xor_b32 v88, 0x80000000, v72
	v_xor_b32 v96, v88, v29
	v_xor_b32 v81, v73, v29
	v_xor_b32 v89, 0x80000000, v73
	v_xor_b32 v97, v89, v29
	s_add_u32 m0, s68, 0x4000
	s_nop 0
	buffer_load_dwordx4 v11, s[44:47], s63 offen lds
	s_add_u32 s63, s63, 0xe000
	v_xor_b32 v82, v74, v29
	v_xor_b32 v90, 0x80000000, v74
	v_xor_b32 v98, v90, v29
	v_xor_b32 v83, v75, v29
	v_xor_b32 v91, 0x80000000, v75
	v_xor_b32 v99, v91, v29
	v_xor_b32 v84, v76, v29
	v_xor_b32 v92, 0x80000000, v76
	v_xor_b32 v100, v92, v29
	v_xor_b32 v85, v77, v29
	s_add_u32 m0, s68, 0x5000
	s_nop 0
	buffer_load_dwordx4 v11, s[44:47], s63 offen lds
	s_add_u32 s63, s63, 0xe000
	v_xor_b32 v93, 0x80000000, v77
	v_xor_b32 v101, v93, v29
	v_xor_b32 v86, v78, v29
	v_xor_b32 v94, 0x80000000, v78
	v_xor_b32 v102, v94, v29
	v_xor_b32 v87, v79, v29
	v_xor_b32 v95, 0x80000000, v79
	v_xor_b32 v103, v95, v29
	v_add_f32 v28, 0, v24
	v_mul_f32 v28, 0x3a000000, v28
	s_add_u32 m0, s68, 0x6000
	s_nop 0
	buffer_load_dwordx4 v11, s[44:47], s63 offen lds
	s_add_u32 s63, s63, 0xe000
	v_mul_f32 v27, v38, v28
	v_cos_f32 v120, v27
	v_sin_f32 v128, v27
	v_add_f32 v27, v27, v28
	v_cos_f32 v121, v27
	v_sin_f32 v129, v27
	v_add_f32 v27, v27, v28
	v_cos_f32 v122, v27
	v_sin_f32 v130, v27
	v_add_f32 v27, v27, v28
	s_add_u32 m0, s68, 0x7000
	s_nop 0
	buffer_load_dwordx4 v11, s[44:47], s63 offen lds
	s_add_u32 s63, s63, 0xe000
	v_cos_f32 v123, v27
	v_sin_f32 v131, v27
	v_add_f32 v28, 0x41800000, v24
	v_mul_f32 v28, 0x3a000000, v28
	v_mul_f32 v27, v38, v28
	v_cos_f32 v124, v27
	v_sin_f32 v132, v27
	v_add_f32 v27, v27, v28
	v_cos_f32 v125, v27
	v_sin_f32 v133, v27
	v_add_f32 v27, v27, v28
	v_cos_f32 v126, v27
	v_sin_f32 v134, v27
	v_add_f32 v27, v27, v28
	v_cos_f32 v127, v27
	v_sin_f32 v135, v27
	v_lshrrev_b32 v2, 3, v1
	v_lshlrev_b32 v142, 9, v2
	v_and_b32 v2, 7, v1
	v_xor_b32 v2, v2, v5
	v_lshl_add_u32 v142, v2, 4, v142
	v_xor_b32 v143, 64, v142
	s_lshl_b32 s81, s80, 14
	s_lshl_b32 s60, s3, 7
	s_add_u32 s81, s81, s60
	v_lshrrev_b32 v2, 1, v1
	v_and_b32 v3, 1, v1
	v_lshlrev_b32 v3, 5, v3
	v_lshl_add_u32 v144, v2, 7, v3
	s_lshl_b32 s86, s80, 14
	s_lshl_b32 s60, s3, 12
	s_add_u32 s86, s86, s60
	s_cmp_lg_u32 s3, 0
	s_cbranch_scc1 sequential_preLN__spectral_gfnet__mixer_channel_mlp__prompt_kernel_npf1
	s_waitcnt lgkmcnt(0)
	s_and_b32 s61, s2, 31
	s_lshl_b32 s61, s61, 10
	s_add_u32 s61, s61, 0x30000
	s_add_u32 s16, s6, s61
	s_addc_u32 s17, s7, 0
	s_mov_b32 s62, 0x80000
sequential_preLN__spectral_gfnet__mixer_channel_mlp__prompt_kernel_pollyf1:
	s_load_dword s64, s[16:17], 0 glc
	s_load_dword s65, s[16:17], 0x80 glc
	s_load_dword s66, s[16:17], 0x100 glc
	s_load_dword s67, s[16:17], 0x180 glc
	s_load_dword s12, s[16:17], 0x200 glc
	s_load_dword s13, s[16:17], 0x280 glc
	s_load_dword s14, s[16:17], 0x300 glc
	s_load_dword s15, s[16:17], 0x380 glc
	s_waitcnt lgkmcnt(0)
	s_min_u32 s64, s64, s65
	s_min_u32 s66, s66, s67
	s_min_u32 s12, s12, s13
	s_min_u32 s14, s14, s15
	s_min_u32 s64, s64, s66
	s_min_u32 s12, s12, s14
	s_min_u32 s64, s64, s12
	s_cmp_ge_u32 s64, 32
	s_cbranch_scc1 sequential_preLN__spectral_gfnet__mixer_channel_mlp__prompt_kernel_npf1
	s_sub_u32 s62, s62, 1
	s_cmp_lg_u32 s62, 0
	s_cbranch_scc1 sequential_preLN__spectral_gfnet__mixer_channel_mlp__prompt_kernel_pollyf1
sequential_preLN__spectral_gfnet__mixer_channel_mlp__prompt_kernel_npf1:
	s_barrier
	s_mov_b32 s52, s24
	s_mov_b32 s53, s25
	s_mov_b32 s54, 0x204000
	s_mov_b32 s55, 0x20000
	s_lshl_b32 s61, s3, 12
	s_add_u32 m0, s61, 0x20000
	s_add_u32 s60, s81, 0
	buffer_load_dwordx4 v142, s[52:55], s60 offen sc1 lds
	s_add_u32 m0, s61, 0x20400
	s_add_u32 s60, s81, 0x1000
	buffer_load_dwordx4 v143, s[52:55], s60 offen sc1 lds
	s_add_u32 m0, s61, 0x20800
	s_add_u32 s60, s81, 0x2000
	buffer_load_dwordx4 v142, s[52:55], s60 offen sc1 lds
	s_add_u32 m0, s61, 0x20c00
	s_add_u32 s60, s81, 0x3000
	buffer_load_dwordx4 v143, s[52:55], s60 offen sc1 lds
	s_add_u32 s56, s24, 0x208000
	s_addc_u32 s57, s25, 0
	s_mov_b32 s58, 0x204000
	s_mov_b32 s59, 0x20000
	s_cmp_eq_u32 s80, 0
	s_cselect_b32 s60, 0x200000, 0
	s_add_u32 s60, s60, s86
	buffer_load_dwordx4 v[146:149], v144, s[56:59], s60 offen sc1
	buffer_load_dwordx4 v[150:153], v144, s[56:59], s60 offen offset:16 sc1
	buffer_load_dwordx4 v[154:157], v144, s[56:59], s86 offen offset:64 sc1
	buffer_load_dwordx4 v[158:161], v144, s[56:59], s86 offen offset:80 sc1
	s_add_u32 s48, s24, 0x410000
	s_addc_u32 s49, s25, 0
	s_mov_b32 s50, 0x200000
	s_mov_b32 s51, 0x20000
	s_waitcnt vmcnt(4)
	s_barrier
	ds_read_b128 a[0:3], v136
	ds_read_b128 a[4:7], v136 offset:4096
	ds_read_b128 a[8:11], v136 offset:8192
	ds_read_b128 a[12:15], v136 offset:12288
	ds_read_b128 a[16:19], v136 offset:2048
	ds_read_b128 a[20:23], v136 offset:6144
	ds_read_b128 a[24:27], v136 offset:10240
	ds_read_b128 a[28:31], v136 offset:14336
	ds_read_b128 a[32:35], v137
	ds_read_b128 a[36:39], v137 offset:4096
	ds_read_b128 a[40:43], v137 offset:8192
	ds_read_b128 a[44:47], v137 offset:12288
	ds_read_b128 a[48:51], v137 offset:2048
	ds_read_b128 a[52:55], v137 offset:6144
	ds_read_b128 a[56:59], v137 offset:10240
	ds_read_b128 a[60:63], v137 offset:14336
	s_waitcnt lgkmcnt(15)
	v_mfma_f32_16x16x32_bf16 v[162:165], a[0:3], v[40:43], 0
	v_mfma_f32_16x16x32_bf16 v[166:169], a[0:3], v[44:47], 0
	s_waitcnt lgkmcnt(14)
	v_mfma_f32_16x16x32_bf16 v[162:165], a[4:7], v[48:51], v[162:165]
	v_mfma_f32_16x16x32_bf16 v[166:169], a[4:7], v[52:55], v[166:169]
	s_waitcnt lgkmcnt(13)
	v_mfma_f32_16x16x32_bf16 v[162:165], a[8:11], v[56:59], v[162:165]
	v_mfma_f32_16x16x32_bf16 v[166:169], a[8:11], v[60:63], v[166:169]
	s_waitcnt lgkmcnt(12)
	v_mfma_f32_16x16x32_bf16 v[162:165], a[12:15], v[64:67], v[162:165]
	v_mfma_f32_16x16x32_bf16 v[166:169], a[12:15], v[68:71], v[166:169]
	s_waitcnt lgkmcnt(11)
	v_mfma_f32_16x16x32_bf16 v[170:173], a[16:19], v[40:43], 0
	v_mfma_f32_16x16x32_bf16 v[174:177], a[16:19], v[44:47], 0
	s_waitcnt lgkmcnt(10)
	v_mfma_f32_16x16x32_bf16 v[170:173], a[20:23], v[48:51], v[170:173]
	v_mfma_f32_16x16x32_bf16 v[174:177], a[20:23], v[52:55], v[174:177]
	s_waitcnt lgkmcnt(9)
	v_mfma_f32_16x16x32_bf16 v[170:173], a[24:27], v[56:59], v[170:173]
	v_mfma_f32_16x16x32_bf16 v[174:177], a[24:27], v[60:63], v[174:177]
	s_waitcnt lgkmcnt(8)
	v_mfma_f32_16x16x32_bf16 v[170:173], a[28:31], v[64:67], v[170:173]
	v_mfma_f32_16x16x32_bf16 v[174:177], a[28:31], v[68:71], v[174:177]
	s_waitcnt lgkmcnt(7)
	v_mfma_f32_16x16x32_bf16 v[178:181], a[32:35], v[40:43], 0
	v_mul_f32 v30, v162, v104
	v_mul_f32 v34, v166, v104
	v_mfma_f32_16x16x32_bf16 v[182:185], a[32:35], v[44:47], 0
	v_fmac_f32 v30, v166, v112
	v_fma_f32 v34, -v162, v112, v34
	v_mul_f32 v31, v163, v105
	s_waitcnt lgkmcnt(6)
	v_mfma_f32_16x16x32_bf16 v[178:181], a[36:39], v[48:51], v[178:181]
	v_mul_f32 v35, v167, v105
	v_fmac_f32 v31, v167, v113
	v_mfma_f32_16x16x32_bf16 v[182:185], a[36:39], v[52:55], v[182:185]
	v_fma_f32 v35, -v163, v113, v35
	v_mul_f32 v32, v164, v106
	v_mul_f32 v36, v168, v106
	s_waitcnt lgkmcnt(5)
	v_mfma_f32_16x16x32_bf16 v[178:181], a[40:43], v[56:59], v[178:181]
	v_fmac_f32 v32, v168, v114
	v_fma_f32 v36, -v164, v114, v36
	v_mfma_f32_16x16x32_bf16 v[182:185], a[40:43], v[60:63], v[182:185]
	v_mul_f32 v33, v165, v107
	v_mul_f32 v37, v169, v107
	v_fmac_f32 v33, v169, v115
	s_waitcnt lgkmcnt(4)
	v_mfma_f32_16x16x32_bf16 v[178:181], a[44:47], v[64:67], v[178:181]
	v_fma_f32 v37, -v165, v115, v37
	v_cvt_pk_bf16_f32 v226, v30, v31
	v_mfma_f32_16x16x32_bf16 v[182:185], a[44:47], v[68:71], v[182:185]
	v_cvt_pk_bf16_f32 v227, v34, v35
	v_cvt_pk_bf16_f32 v228, v32, v33
	v_cvt_pk_bf16_f32 v229, v36, v37
	s_waitcnt lgkmcnt(3)
	v_mfma_f32_16x16x32_bf16 v[186:189], a[48:51], v[40:43], 0
	v_mul_f32 v30, v170, v108
	v_mul_f32 v34, v174, v108
	v_mfma_f32_16x16x32_bf16 v[190:193], a[48:51], v[44:47], 0
	v_fmac_f32 v30, v174, v116
	v_fma_f32 v34, -v170, v116, v34
	v_mul_f32 v31, v171, v109
	s_waitcnt lgkmcnt(2)
	v_mfma_f32_16x16x32_bf16 v[186:189], a[52:55], v[48:51], v[186:189]
	v_mul_f32 v35, v175, v109
	v_fmac_f32 v31, v175, v117
	v_mfma_f32_16x16x32_bf16 v[190:193], a[52:55], v[52:55], v[190:193]
	v_fma_f32 v35, -v171, v117, v35
	v_mul_f32 v32, v172, v110
	v_mul_f32 v36, v176, v110
	s_waitcnt lgkmcnt(1)
	v_mfma_f32_16x16x32_bf16 v[186:189], a[56:59], v[56:59], v[186:189]
	v_fmac_f32 v32, v176, v118
	v_fma_f32 v36, -v172, v118, v36
	v_mfma_f32_16x16x32_bf16 v[190:193], a[56:59], v[60:63], v[190:193]
	v_mul_f32 v33, v173, v111
	v_mul_f32 v37, v177, v111
	v_fmac_f32 v33, v177, v119
	s_waitcnt lgkmcnt(0)
	v_mfma_f32_16x16x32_bf16 v[186:189], a[60:63], v[64:67], v[186:189]
	v_fma_f32 v37, -v173, v119, v37
	v_cvt_pk_bf16_f32 v230, v30, v31
	v_mfma_f32_16x16x32_bf16 v[190:193], a[60:63], v[68:71], v[190:193]
	v_cvt_pk_bf16_f32 v231, v34, v35
	v_cvt_pk_bf16_f32 v232, v32, v33
	v_cvt_pk_bf16_f32 v233, v36, v37
	v_mfma_f32_16x16x32_bf16 v[194:197], v[72:75], v[226:229], 0
	v_mul_f32 v30, v178, v104
	v_mul_f32 v34, v182, v104
	v_fmac_f32 v30, v182, v112
	v_fma_f32 v34, -v178, v112, v34
	v_mul_f32 v31, v179, v105
	v_mfma_f32_16x16x32_bf16 v[198:201], v[76:79], v[226:229], 0
	v_mul_f32 v35, v183, v105
	v_fmac_f32 v31, v183, v113
	v_fma_f32 v35, -v179, v113, v35
	v_mul_f32 v32, v180, v106
	v_mul_f32 v36, v184, v106
	v_mfma_f32_16x16x32_bf16 v[202:205], v[88:91], v[226:229], 0
	v_fmac_f32 v32, v184, v114
	v_fma_f32 v36, -v180, v114, v36
	v_mul_f32 v33, v181, v107
	v_mul_f32 v37, v185, v107
	v_fmac_f32 v33, v185, v115
	v_mfma_f32_16x16x32_bf16 v[206:209], v[92:95], v[226:229], 0
	v_fma_f32 v37, -v181, v115, v37
	v_cvt_pk_bf16_f32 v234, v30, v31
	v_cvt_pk_bf16_f32 v235, v34, v35
	v_cvt_pk_bf16_f32 v236, v32, v33
	v_cvt_pk_bf16_f32 v237, v36, v37
	v_mfma_f32_16x16x32_bf16 v[194:197], v[80:83], v[230:233], v[194:197]
	v_mul_f32 v30, v186, v108
	v_mul_f32 v34, v190, v108
	v_fmac_f32 v30, v190, v116
	v_fma_f32 v34, -v186, v116, v34
	v_mul_f32 v31, v187, v109
	v_mfma_f32_16x16x32_bf16 v[198:201], v[84:87], v[230:233], v[198:201]
	v_mul_f32 v35, v191, v109
	v_fmac_f32 v31, v191, v117
	v_fma_f32 v35, -v187, v117, v35
	v_mul_f32 v32, v188, v110
	v_mul_f32 v36, v192, v110
	v_mfma_f32_16x16x32_bf16 v[202:205], v[96:99], v[230:233], v[202:205]
	v_fmac_f32 v32, v192, v118
	v_fma_f32 v36, -v188, v118, v36
	v_mul_f32 v33, v189, v111
	v_mul_f32 v37, v193, v111
	v_fmac_f32 v33, v193, v119
	s_add_u32 m0, s68, 0x8000
	s_nop 0
	buffer_load_dwordx4 v11, s[44:47], s63 offen lds
	s_add_u32 s63, s63, 0xe000
	v_mfma_f32_16x16x32_bf16 v[206:209], v[100:103], v[230:233], v[206:209]
	v_fma_f32 v37, -v189, v119, v37
	v_cvt_pk_bf16_f32 v238, v30, v31
	v_cvt_pk_bf16_f32 v239, v34, v35
	v_cvt_pk_bf16_f32 v240, v32, v33
	v_cvt_pk_bf16_f32 v241, v36, v37
	v_mfma_f32_16x16x32_bf16 v[210:213], v[72:75], v[234:237], 0
	s_waitcnt vmcnt(4)
	v_lshlrev_b32 v24, 16, v146
	v_and_b32 v142, 0xffff0000, v146
	v_lshlrev_b32 v25, 16, v147
	v_and_b32 v143, 0xffff0000, v147
	v_lshlrev_b32 v26, 16, v148
	v_and_b32 v144, 0xffff0000, v148
	v_lshlrev_b32 v27, 16, v149
	s_add_u32 m0, s68, 0x9000
	s_nop 0
	buffer_load_dwordx4 v11, s[44:47], s63 offen lds
	s_add_u32 s63, s63, 0xe000
	v_mfma_f32_16x16x32_bf16 v[214:217], v[76:79], v[234:237], 0
	v_and_b32 v145, 0xffff0000, v149
	v_mul_f32 v30, v194, v24
	v_mul_f32 v34, v194, v142
	v_fma_f32 v30, -v198, v142, v30
	v_fmac_f32 v34, v198, v24
	v_mul_f32 v31, v195, v25
	v_mul_f32 v35, v195, v143
	v_mfma_f32_16x16x32_bf16 v[218:221], v[88:91], v[234:237], 0
	v_fma_f32 v31, -v199, v143, v31
	v_fmac_f32 v35, v199, v25
	v_mul_f32 v32, v196, v26
	v_mul_f32 v36, v196, v144
	v_fma_f32 v32, -v200, v144, v32
	s_add_u32 m0, s68, 0xa000
	s_nop 0
	buffer_load_dwordx4 v11, s[44:47], s63 offen lds
	s_add_u32 s63, s63, 0xe000
	v_fmac_f32 v36, v200, v26
	v_mul_f32 v33, v197, v27
	v_mfma_f32_16x16x32_bf16 v[222:225], v[92:95], v[234:237], 0
	v_mul_f32 v37, v197, v145
	v_fma_f32 v33, -v201, v145, v33
	v_fmac_f32 v37, v201, v27
	v_cvt_pk_bf16_f32 v226, v34, v35
	v_cvt_pk_bf16_f32 v227, v30, v31
	v_cvt_pk_bf16_f32 v228, v36, v37
	v_cvt_pk_bf16_f32 v229, v32, v33
	v_mfma_f32_16x16x32_bf16 v[210:213], v[80:83], v[238:241], v[210:213]
	s_waitcnt vmcnt(5)
	v_lshlrev_b32 v24, 16, v150
	v_and_b32 v142, 0xffff0000, v150
	v_lshlrev_b32 v25, 16, v151
	s_add_u32 m0, s68, 0xb000
	s_nop 0
	buffer_load_dwordx4 v11, s[44:47], s63 offen lds
	s_add_u32 s63, s63, 0xe000
	v_and_b32 v143, 0xffff0000, v151
	v_lshlrev_b32 v26, 16, v152
	v_and_b32 v144, 0xffff0000, v152
	v_lshlrev_b32 v27, 16, v153
	v_mfma_f32_16x16x32_bf16 v[214:217], v[84:87], v[238:241], v[214:217]
	v_and_b32 v145, 0xffff0000, v153
	v_mul_f32 v30, v202, v24
	v_mul_f32 v34, v202, v142
	v_fma_f32 v30, -v206, v142, v30
	v_fmac_f32 v34, v206, v24
	v_mul_f32 v31, v203, v25
	v_mul_f32 v35, v203, v143
	v_mfma_f32_16x16x32_bf16 v[218:221], v[96:99], v[238:241], v[218:221]
	v_fma_f32 v31, -v207, v143, v31
	s_add_u32 m0, s68, 0xc000
	s_nop 0
	buffer_load_dwordx4 v11, s[44:47], s63 offen lds
	s_add_u32 s63, s63, 0xe000
	v_fmac_f32 v35, v207, v25
	v_mul_f32 v32, v204, v26
	v_mul_f32 v36, v204, v144
	v_fma_f32 v32, -v208, v144, v32
	v_fmac_f32 v36, v208, v26
	v_mul_f32 v33, v205, v27
	v_mfma_f32_16x16x32_bf16 v[222:225], v[100:103], v[238:241], v[222:225]
	v_mul_f32 v37, v205, v145
	v_fma_f32 v33, -v209, v145, v33
	v_fmac_f32 v37, v209, v27
	v_cvt_pk_bf16_f32 v230, v34, v35
	v_cvt_pk_bf16_f32 v231, v30, v31
	v_cvt_pk_bf16_f32 v232, v36, v37
	v_cvt_pk_bf16_f32 v233, v32, v33
	s_add_u32 m0, s68, 0xd000
	s_nop 0
	buffer_load_dwordx4 v11, s[44:47], s63 offen lds
	s_add_u32 s63, s63, 0xe000
	v_mfma_f32_16x16x32_bf16 v[162:165], v[226:229], v[76:79], 0
	s_waitcnt vmcnt(7)
	v_lshlrev_b32 v24, 16, v154
	v_and_b32 v142, 0xffff0000, v154
	v_lshlrev_b32 v25, 16, v155
	v_and_b32 v143, 0xffff0000, v155
	v_lshlrev_b32 v26, 16, v156
	v_and_b32 v144, 0xffff0000, v156
	v_lshlrev_b32 v27, 16, v157
	v_mfma_f32_16x16x32_bf16 v[166:169], v[226:229], v[72:75], 0
	v_and_b32 v145, 0xffff0000, v157
	v_mul_f32 v30, v210, v24
	v_mul_f32 v34, v210, v142
	v_fma_f32 v30, -v214, v142, v30
	v_fmac_f32 v34, v214, v24
	s_add_u32 m0, s68, 0xe000
	s_nop 0
	buffer_load_dwordx4 v11, s[44:47], s63 offen lds
	s_add_u32 s63, s63, 0xe000
	v_mul_f32 v31, v211, v25
	v_mul_f32 v35, v211, v143
	v_mfma_f32_16x16x32_bf16 v[170:173], v[226:229], v[92:95], 0
	v_fma_f32 v31, -v215, v143, v31
	v_fmac_f32 v35, v215, v25
	v_mul_f32 v32, v212, v26
	v_mul_f32 v36, v212, v144
	v_fma_f32 v32, -v216, v144, v32
	v_fmac_f32 v36, v216, v26
	v_mul_f32 v33, v213, v27
	v_mfma_f32_16x16x32_bf16 v[174:177], v[226:229], v[88:91], 0
	v_mul_f32 v37, v213, v145
	v_fma_f32 v33, -v217, v145, v33
	v_fmac_f32 v37, v217, v27
	s_add_u32 m0, s68, 0xf000
	s_nop 0
	buffer_load_dwordx4 v11, s[44:47], s63 offen lds
	s_add_u32 s63, s63, 0xe000
	v_cvt_pk_bf16_f32 v234, v34, v35
	v_cvt_pk_bf16_f32 v235, v30, v31
	v_cvt_pk_bf16_f32 v236, v36, v37
	v_cvt_pk_bf16_f32 v237, v32, v33
	v_mfma_f32_16x16x32_bf16 v[162:165], v[230:233], v[84:87], v[162:165]
	s_waitcnt vmcnt(8)
	v_lshlrev_b32 v24, 16, v158
	v_and_b32 v142, 0xffff0000, v158
	v_lshlrev_b32 v25, 16, v159
	v_and_b32 v143, 0xffff0000, v159
	v_lshlrev_b32 v26, 16, v160
	v_and_b32 v144, 0xffff0000, v160
	v_lshlrev_b32 v27, 16, v161
	v_mfma_f32_16x16x32_bf16 v[166:169], v[230:233], v[80:83], v[166:169]
	v_and_b32 v145, 0xffff0000, v161
	s_xor_b32 s68, s68, 0x10000
	s_sub_u32 s63, s63, s23
	s_add_u32 m0, s68, 0
	s_nop 0
	buffer_load_dwordx4 v11, s[44:47], s63 offen lds
	s_add_u32 s63, s63, 0xe000
	v_mul_f32 v30, v218, v24
	v_mul_f32 v34, v218, v142
	v_fma_f32 v30, -v222, v142, v30
	v_fmac_f32 v34, v222, v24
	v_mul_f32 v31, v219, v25
	v_mul_f32 v35, v219, v143
	v_mfma_f32_16x16x32_bf16 v[170:173], v[230:233], v[100:103], v[170:173]
	v_fma_f32 v31, -v223, v143, v31
	v_fmac_f32 v35, v223, v25
	v_mul_f32 v32, v220, v26
	v_mul_f32 v36, v220, v144
	v_fma_f32 v32, -v224, v144, v32
	v_fmac_f32 v36, v224, v26
	v_mul_f32 v33, v221, v27
	s_add_u32 m0, s68, 0x1000
	s_nop 0
	buffer_load_dwordx4 v11, s[44:47], s63 offen lds
	s_add_u32 s63, s63, 0xe000
	v_mfma_f32_16x16x32_bf16 v[174:177], v[230:233], v[96:99], v[174:177]
	v_mul_f32 v37, v221, v145
	v_fma_f32 v33, -v225, v145, v33
	v_fmac_f32 v37, v225, v27
	v_cvt_pk_bf16_f32 v238, v34, v35
	v_cvt_pk_bf16_f32 v239, v30, v31
	v_cvt_pk_bf16_f32 v240, v36, v37
	v_cvt_pk_bf16_f32 v241, v32, v33
	v_mfma_f32_16x16x32_bf16 v[178:181], v[234:237], v[76:79], 0
	v_mul_f32 v30, v162, v120
	v_mul_f32 v34, v166, v120
	v_fma_f32 v30, -v166, v128, v30
	v_fmac_f32 v34, v162, v128
	v_mul_f32 v31, v163, v121
	s_add_u32 m0, s68, 0x2000
	s_nop 0
	buffer_load_dwordx4 v11, s[44:47], s63 offen lds
	s_add_u32 s63, s63, 0xe000
	v_mfma_f32_16x16x32_bf16 v[182:185], v[234:237], v[72:75], 0
	v_mul_f32 v35, v167, v121
	v_fma_f32 v31, -v167, v129, v31
	v_fmac_f32 v35, v163, v129
	v_mul_f32 v32, v164, v122
	v_mul_f32 v36, v168, v122
	v_mfma_f32_16x16x32_bf16 v[186:189], v[234:237], v[92:95], 0
	v_fma_f32 v32, -v168, v130, v32
	v_fmac_f32 v36, v164, v130
	v_mul_f32 v33, v165, v123
	v_mul_f32 v37, v169, v123
	v_fma_f32 v33, -v169, v131, v33
	v_mfma_f32_16x16x32_bf16 v[190:193], v[234:237], v[88:91], 0
	v_fmac_f32 v37, v165, v131
	s_add_u32 m0, s68, 0x3000
	s_nop 0
	buffer_load_dwordx4 v11, s[44:47], s63 offen lds
	s_add_u32 s63, s63, 0xe000
	v_cvt_pk_bf16_f32 v226, v34, v35
	v_cvt_pk_bf16_f32 v227, v30, v31
	v_cvt_pk_bf16_f32 v228, v36, v37
	v_cvt_pk_bf16_f32 v229, v32, v33
	ds_write_b128 v39, v[226:229] offset:16384
	v_mfma_f32_16x16x32_bf16 v[178:181], v[238:241], v[84:87], v[178:181]
	v_mul_f32 v30, v170, v124
	v_mul_f32 v34, v174, v124
	v_fma_f32 v30, -v174, v132, v30
	v_fmac_f32 v34, v170, v132
	v_mul_f32 v31, v171, v125
	v_mfma_f32_16x16x32_bf16 v[182:185], v[238:241], v[80:83], v[182:185]
	v_mul_f32 v35, v175, v125
	v_fma_f32 v31, -v175, v133, v31
	v_fmac_f32 v35, v171, v133
	v_mul_f32 v32, v172, v126
	v_mul_f32 v36, v176, v126
	v_mfma_f32_16x16x32_bf16 v[186:189], v[238:241], v[100:103], v[186:189]
	v_fma_f32 v32, -v176, v134, v32
	v_fmac_f32 v36, v172, v134
	v_mul_f32 v33, v173, v127
	v_mul_f32 v37, v177, v127
	v_fma_f32 v33, -v177, v135, v33
	v_mfma_f32_16x16x32_bf16 v[190:193], v[238:241], v[96:99], v[190:193]
	v_fmac_f32 v37, v173, v135
	v_cvt_pk_bf16_f32 v230, v34, v35
	v_cvt_pk_bf16_f32 v231, v30, v31
	v_cvt_pk_bf16_f32 v232, v36, v37
	v_cvt_pk_bf16_f32 v233, v32, v33
	ds_write_b128 v39, v[230:233] offset:20480
	v_mul_f32 v30, v178, v120
	v_mul_f32 v34, v182, v120
	v_fma_f32 v30, -v182, v128, v30
	v_fmac_f32 v34, v178, v128
	v_mul_f32 v31, v179, v121
	v_mul_f32 v35, v183, v121
	v_fma_f32 v31, -v183, v129, v31
	v_fmac_f32 v35, v179, v129
	v_mul_f32 v32, v180, v122
	v_mul_f32 v36, v184, v122
	v_fma_f32 v32, -v184, v130, v32
	v_fmac_f32 v36, v180, v130
	v_mul_f32 v33, v181, v123
	v_mul_f32 v37, v185, v123
	v_fma_f32 v33, -v185, v131, v33
	v_fmac_f32 v37, v181, v131
	v_cvt_pk_bf16_f32 v234, v34, v35
	v_cvt_pk_bf16_f32 v235, v30, v31
	v_cvt_pk_bf16_f32 v236, v36, v37
	v_cvt_pk_bf16_f32 v237, v32, v33
	ds_write_b128 v39, v[234:237] offset:24576
	v_mul_f32 v30, v186, v124
	v_mul_f32 v34, v190, v124
	v_fma_f32 v30, -v190, v132, v30
	v_fmac_f32 v34, v186, v132
	v_mul_f32 v31, v187, v125
	v_mul_f32 v35, v191, v125
	v_fma_f32 v31, -v191, v133, v31
	v_fmac_f32 v35, v187, v133
	v_mul_f32 v32, v188, v126
	v_mul_f32 v36, v192, v126
	v_fma_f32 v32, -v192, v134, v32
	v_fmac_f32 v36, v188, v134
	v_mul_f32 v33, v189, v127
	v_mul_f32 v37, v193, v127
	v_fma_f32 v33, -v193, v135, v33
	v_fmac_f32 v37, v189, v135
	v_cvt_pk_bf16_f32 v238, v34, v35
	v_cvt_pk_bf16_f32 v239, v30, v31
	v_cvt_pk_bf16_f32 v240, v36, v37
	v_cvt_pk_bf16_f32 v241, v32, v33
	ds_write_b128 v39, v[238:241] offset:28672
	s_waitcnt lgkmcnt(0)
	s_barrier
	ds_read_b128 a[0:3], v138 offset:16384
	ds_read_b128 a[4:7], v138 offset:17408
	ds_read_b128 a[8:11], v138 offset:18432
	ds_read_b128 a[12:15], v138 offset:19456
	ds_read_b128 a[16:19], v138 offset:20480
	ds_read_b128 a[20:23], v138 offset:21504
	ds_read_b128 a[24:27], v138 offset:22528
	ds_read_b128 a[28:31], v138 offset:23552
	ds_read_b128 a[32:35], v138 offset:24576
	ds_read_b128 a[36:39], v138 offset:25600
	ds_read_b128 a[40:43], v138 offset:26624
	ds_read_b128 a[44:47], v138 offset:27648
	ds_read_b128 a[48:51], v138 offset:28672
	ds_read_b128 a[52:55], v138 offset:29696
	ds_read_b128 a[56:59], v138 offset:30720
	ds_read_b128 a[60:63], v138 offset:31744
	s_cmp_eq_u32 s80, 0x80
	s_cbranch_scc1 sequential_preLN__spectral_gfnet__mixer_channel_mlp__prompt_kernel_spst
	s_waitcnt lgkmcnt(15)
	v_mfma_f32_16x16x32_bf16 v[194:197], v[44:47], a[0:3], 0
	v_mfma_f32_16x16x32_bf16 v[198:201], v[40:43], a[0:3], 0
	s_waitcnt lgkmcnt(14)
	v_mfma_f32_16x16x32_bf16 v[194:197], v[52:55], a[4:7], v[194:197]
	v_mfma_f32_16x16x32_bf16 v[198:201], v[48:51], a[4:7], v[198:201]
	s_waitcnt lgkmcnt(13)
	v_mfma_f32_16x16x32_bf16 v[194:197], v[60:63], a[8:11], v[194:197]
	v_mfma_f32_16x16x32_bf16 v[198:201], v[56:59], a[8:11], v[198:201]
	s_waitcnt lgkmcnt(12)
	v_mfma_f32_16x16x32_bf16 v[194:197], v[68:71], a[12:15], v[194:197]
	v_mfma_f32_16x16x32_bf16 v[198:201], v[64:67], a[12:15], v[198:201]
	s_waitcnt lgkmcnt(7)
	v_mfma_f32_16x16x32_bf16 v[210:213], v[44:47], a[32:35], 0
	v_mfma_f32_16x16x32_bf16 v[214:217], v[40:43], a[32:35], 0
	s_waitcnt lgkmcnt(6)
	v_mfma_f32_16x16x32_bf16 v[210:213], v[52:55], a[36:39], v[210:213]
	v_mfma_f32_16x16x32_bf16 v[214:217], v[48:51], a[36:39], v[214:217]
	s_waitcnt lgkmcnt(5)
	v_mfma_f32_16x16x32_bf16 v[210:213], v[60:63], a[40:43], v[210:213]
	v_mfma_f32_16x16x32_bf16 v[214:217], v[56:59], a[40:43], v[214:217]
	s_waitcnt lgkmcnt(4)
	v_mfma_f32_16x16x32_bf16 v[210:213], v[68:71], a[44:47], v[210:213]
	v_mfma_f32_16x16x32_bf16 v[214:217], v[64:67], a[44:47], v[214:217]
	v_cvt_pk_bf16_f32 v226, v194, v195
	v_cvt_pk_bf16_f32 v227, v198, v199
	v_cvt_pk_bf16_f32 v228, v196, v197
	v_cvt_pk_bf16_f32 v229, v200, v201
	v_mfma_f32_16x16x32_bf16 v[202:205], v[44:47], a[16:19], 0
	v_mfma_f32_16x16x32_bf16 v[206:209], v[40:43], a[16:19], 0
	v_mfma_f32_16x16x32_bf16 v[202:205], v[52:55], a[20:23], v[202:205]
	v_mfma_f32_16x16x32_bf16 v[206:209], v[48:51], a[20:23], v[206:209]
	v_mfma_f32_16x16x32_bf16 v[202:205], v[60:63], a[24:27], v[202:205]
	v_mfma_f32_16x16x32_bf16 v[206:209], v[56:59], a[24:27], v[206:209]
	v_mfma_f32_16x16x32_bf16 v[202:205], v[68:71], a[28:31], v[202:205]
	v_mfma_f32_16x16x32_bf16 v[206:209], v[64:67], a[28:31], v[206:209]
	v_cvt_pk_bf16_f32 v234, v210, v211
	v_cvt_pk_bf16_f32 v235, v214, v215
	v_cvt_pk_bf16_f32 v236, v212, v213
	v_cvt_pk_bf16_f32 v237, v216, v217
	v_mov_b32 v30, v226
	v_mov_b32 v31, v227
	v_mov_b32 v32, v228
	v_mov_b32 v33, v229
	v_mov_b32_dpp v226, v234 row_ror:8 row_mask:0xf bank_mask:0xc
	v_mov_b32_dpp v227, v235 row_ror:8 row_mask:0xf bank_mask:0xc
	v_mov_b32_dpp v228, v236 row_ror:8 row_mask:0xf bank_mask:0xc
	v_mov_b32_dpp v229, v237 row_ror:8 row_mask:0xf bank_mask:0xc
	v_mov_b32_dpp v234, v30 row_ror:8 row_mask:0xf bank_mask:0x3
	v_mov_b32_dpp v235, v31 row_ror:8 row_mask:0xf bank_mask:0x3
	v_mov_b32_dpp v236, v32 row_ror:8 row_mask:0xf bank_mask:0x3
	v_mov_b32_dpp v237, v33 row_ror:8 row_mask:0xf bank_mask:0x3
	buffer_store_dwordx4 v[226:229], v141, s[48:51], s82 offen sc1
	buffer_store_dwordx4 v[234:237], v141, s[48:51], s84 offen sc1
	s_waitcnt lgkmcnt(3)
	v_mfma_f32_16x16x32_bf16 v[218:221], v[44:47], a[48:51], 0
	v_mfma_f32_16x16x32_bf16 v[222:225], v[40:43], a[48:51], 0
	s_waitcnt lgkmcnt(2)
	v_mfma_f32_16x16x32_bf16 v[218:221], v[52:55], a[52:55], v[218:221]
	v_mfma_f32_16x16x32_bf16 v[222:225], v[48:51], a[52:55], v[222:225]
	s_waitcnt lgkmcnt(1)
	v_mfma_f32_16x16x32_bf16 v[218:221], v[60:63], a[56:59], v[218:221]
	v_mfma_f32_16x16x32_bf16 v[222:225], v[56:59], a[56:59], v[222:225]
	s_waitcnt lgkmcnt(0)
	v_mfma_f32_16x16x32_bf16 v[218:221], v[68:71], a[60:63], v[218:221]
	v_mfma_f32_16x16x32_bf16 v[222:225], v[64:67], a[60:63], v[222:225]
	v_cvt_pk_bf16_f32 v230, v202, v203
	v_cvt_pk_bf16_f32 v231, v206, v207
	v_cvt_pk_bf16_f32 v232, v204, v205
	v_cvt_pk_bf16_f32 v233, v208, v209
	s_nop 2
	v_cvt_pk_bf16_f32 v238, v218, v219
	v_cvt_pk_bf16_f32 v239, v222, v223
	v_cvt_pk_bf16_f32 v240, v220, v221
	v_cvt_pk_bf16_f32 v241, v224, v225
	v_mov_b32 v30, v230
	v_mov_b32 v31, v231
	v_mov_b32 v32, v232
	v_mov_b32 v33, v233
	v_mov_b32_dpp v230, v238 row_ror:8 row_mask:0xf bank_mask:0xc
	v_mov_b32_dpp v231, v239 row_ror:8 row_mask:0xf bank_mask:0xc
	v_mov_b32_dpp v232, v240 row_ror:8 row_mask:0xf bank_mask:0xc
	v_mov_b32_dpp v233, v241 row_ror:8 row_mask:0xf bank_mask:0xc
	v_mov_b32_dpp v238, v30 row_ror:8 row_mask:0xf bank_mask:0x3
	v_mov_b32_dpp v239, v31 row_ror:8 row_mask:0xf bank_mask:0x3
	v_mov_b32_dpp v240, v32 row_ror:8 row_mask:0xf bank_mask:0x3
	v_mov_b32_dpp v241, v33 row_ror:8 row_mask:0xf bank_mask:0x3
	buffer_store_dwordx4 v[230:233], v141, s[48:51], s83 offen sc1
	buffer_store_dwordx4 v[238:241], v141, s[48:51], s85 offen sc1
	s_branch sequential_preLN__spectral_gfnet__mixer_channel_mlp__prompt_kernel_stend

sequential_preLN__spectral_gfnet__mixer_channel_mlp__prompt_kernel_spst:
	s_waitcnt lgkmcnt(15)
	v_mfma_f32_16x16x32_bf16 v[194:197], v[44:47], a[0:3], 0
	v_mfma_f32_16x16x32_bf16 v[198:201], v[40:43], a[0:3], 0
	s_waitcnt lgkmcnt(14)
	v_mfma_f32_16x16x32_bf16 v[194:197], v[52:55], a[4:7], v[194:197]
	v_mfma_f32_16x16x32_bf16 v[198:201], v[48:51], a[4:7], v[198:201]
	s_waitcnt lgkmcnt(13)
	v_mfma_f32_16x16x32_bf16 v[194:197], v[60:63], a[8:11], v[194:197]
	v_mfma_f32_16x16x32_bf16 v[198:201], v[56:59], a[8:11], v[198:201]
	s_waitcnt lgkmcnt(12)
	v_mfma_f32_16x16x32_bf16 v[194:197], v[68:71], a[12:15], v[194:197]
	v_mfma_f32_16x16x32_bf16 v[198:201], v[64:67], a[12:15], v[198:201]
	s_waitcnt lgkmcnt(7)
	v_mfma_f32_16x16x32_bf16 v[210:213], v[44:47], a[32:35], 0
	v_mfma_f32_16x16x32_bf16 v[214:217], v[40:43], a[32:35], 0
	s_waitcnt lgkmcnt(6)
	v_mfma_f32_16x16x32_bf16 v[210:213], v[52:55], a[36:39], v[210:213]
	v_mfma_f32_16x16x32_bf16 v[214:217], v[48:51], a[36:39], v[214:217]
	s_waitcnt lgkmcnt(5)
	v_mfma_f32_16x16x32_bf16 v[210:213], v[60:63], a[40:43], v[210:213]
	v_mfma_f32_16x16x32_bf16 v[214:217], v[56:59], a[40:43], v[214:217]
	s_waitcnt lgkmcnt(4)
	v_mfma_f32_16x16x32_bf16 v[210:213], v[68:71], a[44:47], v[210:213]
	v_mfma_f32_16x16x32_bf16 v[214:217], v[64:67], a[44:47], v[214:217]
	v_mfma_f32_16x16x32_bf16 v[202:205], v[44:47], a[16:19], 0
	v_mfma_f32_16x16x32_bf16 v[206:209], v[40:43], a[16:19], 0
	v_mfma_f32_16x16x32_bf16 v[202:205], v[52:55], a[20:23], v[202:205]
	v_mfma_f32_16x16x32_bf16 v[206:209], v[48:51], a[20:23], v[206:209]
	v_mfma_f32_16x16x32_bf16 v[202:205], v[60:63], a[24:27], v[202:205]
	v_mfma_f32_16x16x32_bf16 v[206:209], v[56:59], a[24:27], v[206:209]
	v_mfma_f32_16x16x32_bf16 v[202:205], v[68:71], a[28:31], v[202:205]
	v_mfma_f32_16x16x32_bf16 v[206:209], v[64:67], a[28:31], v[206:209]
	s_waitcnt lgkmcnt(3)
	v_mfma_f32_16x16x32_bf16 v[218:221], v[44:47], a[48:51], 0
	v_mfma_f32_16x16x32_bf16 v[222:225], v[40:43], a[48:51], 0
	s_waitcnt lgkmcnt(2)
	v_mfma_f32_16x16x32_bf16 v[218:221], v[52:55], a[52:55], v[218:221]
	v_mfma_f32_16x16x32_bf16 v[222:225], v[48:51], a[52:55], v[222:225]
	s_waitcnt lgkmcnt(1)
	v_mfma_f32_16x16x32_bf16 v[218:221], v[60:63], a[56:59], v[218:221]
	v_mfma_f32_16x16x32_bf16 v[222:225], v[56:59], a[56:59], v[222:225]
	s_waitcnt lgkmcnt(0)
	v_mfma_f32_16x16x32_bf16 v[218:221], v[68:71], a[60:63], v[218:221]
	v_mfma_f32_16x16x32_bf16 v[222:225], v[64:67], a[60:63], v[222:225]
	v_cvt_pk_bf16_f32 v226, v194, v195
	v_cvt_pk_bf16_f32 v227, v210, v211
	v_cvt_pk_bf16_f32 v228, v196, v197
	v_cvt_pk_bf16_f32 v229, v212, v213
	buffer_store_dwordx4 v[226:229], v139, s[48:51], s82 offen sc1
	v_cvt_pk_bf16_f32 v230, v202, v203
	s_nop 0
	v_cvt_pk_bf16_f32 v231, v218, v219
	v_cvt_pk_bf16_f32 v232, v204, v205
	v_cvt_pk_bf16_f32 v233, v220, v221
	buffer_store_dwordx4 v[230:233], v139, s[48:51], s83 offen sc1
sequential_preLN__spectral_gfnet__mixer_channel_mlp__prompt_kernel_stend:
	s_nop 1
	v_cvt_f32_u32 v24, v4
	v_cvt_f32_u32 v25, v5
	v_mul_f32 v26, v24, v25
	v_cmp_gt_u32 s[80:81], 2, v5
	s_mov_b64 s[82:83], 0xffff
	v_cmp_eq_u32 s[84:85], 0, v4
	v_mul_f32 v27, 0x3e800000, v26
	v_mul_f32 v28, 0x3d800000, v24
	v_cos_f32 v30, v27
	v_sin_f32 v34, v27
	v_add_f32 v27, v27, v28
	v_cos_f32 v31, v27
	v_sin_f32 v35, v27
	v_add_f32 v27, v27, v28
	v_cos_f32 v32, v27
	v_sin_f32 v36, v27
	v_add_f32 v27, v27, v28
	v_cos_f32 v33, v27
	v_sin_f32 v37, v27
	v_mov_b32 v3, 0x80008000
	v_cndmask_b32 v2, v3, 0, s[80:81]
	v_xor_b32 v3, v3, v2
	v_cvt_pk_bf16_f32 v38, v30, v31
	v_cvt_pk_bf16_f32 v42, v34, v35
	v_xor_b32 v40, v42, v3
	v_xor_b32 v44, v38, v2
	v_cvt_pk_bf16_f32 v39, v32, v33
	v_cvt_pk_bf16_f32 v43, v36, v37
	v_xor_b32 v41, v43, v3
	v_xor_b32 v45, v39, v2
	v_mul_f32 v2, 0x41000000, v25
	v_add_f32 v3, 0xc1700000, v2
	v_cndmask_b32 v2, v3, v2, s[80:81]
	v_mul_f32 v27, v2, v24
	v_mul_f32 v27, 0x3d000000, v27
	v_cos_f32 v30, v27
	v_sin_f32 v34, v27
	v_add_f32 v27, v27, v28
	v_cos_f32 v31, v27
	v_sin_f32 v35, v27
	v_add_f32 v27, v27, v28
	v_cos_f32 v32, v27
	v_sin_f32 v36, v27
	v_add_f32 v27, v27, v28
	v_cos_f32 v33, v27
	v_sin_f32 v37, v27
	v_and_b32 v29, 1, v4
	v_lshlrev_b32 v29, 31, v29
	v_or_b32 v29, 1.0, v29
	v_mul_f32 v30, 2.0, v30
	v_mul_f32 v34, -2.0, v34
	v_mul_f32 v31, 2.0, v31
	v_mul_f32 v35, -2.0, v35
	v_mul_f32 v32, 2.0, v32
	v_mul_f32 v36, -2.0, v36
	v_mul_f32 v33, 2.0, v33
	v_mul_f32 v37, -2.0, v37
	v_cndmask_b32 v30, v30, 1.0, s[82:83]
	v_cndmask_b32 v34, v34, v29, s[82:83]
	v_cvt_pk_bf16_f32 v2, v30, v31
	v_cvt_pk_bf16_f32 v3, v34, v35
	v_cndmask_b32 v46, 0, v2, s[80:81]
	v_cndmask_b32 v50, v2, 0, s[80:81]
	v_cndmask_b32 v48, 0, v3, s[80:81]
	v_cndmask_b32 v52, v3, 0, s[80:81]
	v_cvt_pk_bf16_f32 v2, v32, v33
	v_cvt_pk_bf16_f32 v3, v36, v37
	v_cndmask_b32 v47, 0, v2, s[80:81]
	v_cndmask_b32 v51, v2, 0, s[80:81]
	v_cndmask_b32 v49, 0, v3, s[80:81]
	v_cndmask_b32 v53, v3, 0, s[80:81]
	v_mul_f32 v27, 0x3c000000, v26
	v_mul_f32 v28, 0x3b000000, v24
	v_cos_f32 v54, v27
	v_sin_f32 v58, v27
	v_add_f32 v27, v27, v28
	v_cos_f32 v55, v27
	v_sin_f32 v59, v27
	v_add_f32 v27, v27, v28
	v_cos_f32 v56, v27
	v_sin_f32 v60, v27
	v_add_f32 v27, v27, v28
	v_cos_f32 v57, v27
	v_sin_f32 v61, v27
	v_mul_f32 v54, 0x35800000, v54
	v_mul_f32 v58, 0x35800000, v58
	v_mul_f32 v55, 0x35800000, v55
	v_mul_f32 v59, 0x35800000, v59
	v_mul_f32 v56, 0x35800000, v56
	v_mul_f32 v60, 0x35800000, v60
	v_mul_f32 v57, 0x35800000, v57
	v_mul_f32 v61, 0x35800000, v61
	s_waitcnt vmcnt(0)
	s_barrier
	s_cmp_lg_u32 s3, 0
	s_cbranch_scc1 sequential_preLN__spectral_gfnet__mixer_channel_mlp__prompt_kernel_nsy
	v_lshlrev_b32 v2, 10, v1
	v_mov_b32 v3, 0x10000000
	v_cmp_gt_u32 vcc, 32, v1
	s_nop 1
	v_cndmask_b32 v2, v3, v2, vcc
	s_and_b32 s60, s2, 7
	s_lshl_b32 s60, s60, 7
	s_add_u32 s60, s60, 0x28000
	buffer_atomic_add v9, v2, s[28:31], s60 offen sc1
sequential_preLN__spectral_gfnet__mixer_channel_mlp__prompt_kernel_nsy:
	s_mov_b32 s48, s10
	s_mov_b32 s49, s11
	s_mov_b32 s50, 0xe00
	s_mov_b32 s51, 0x20000
	s_lshl_b32 s60, s78, 8
	s_lshl_b32 s61, s3, 6
	s_add_u32 s60, s60, s61
	buffer_load_dwordx2 v[248:249], v10, s[48:51], s60 offen
	buffer_load_dwordx2 v[250:251], v10, s[48:51], s60 offen offset:16
	buffer_load_dwordx2 v[252:253], v10, s[48:51], s60 offen offset:32
	buffer_load_dwordx2 v[254:255], v10, s[48:51], s60 offen offset:48
	v_bfe_u32 v2, v1, 2, 2
	v_lshrrev_b32 v3, 5, v1
	v_lshl_add_u32 v3, v3, 4, v2
	v_lshlrev_b32 v14, 8, v3
	v_and_b32 v3, 3, v1
	v_lshl_add_u32 v14, v3, 3, v14
	v_bfe_u32 v3, v1, 4, 1
	v_lshl_add_u32 v14, v3, 5, v14
	v_xor_b32 v2, s3, v2
	v_lshl_add_u32 v14, v2, 6, v14
	v_add_u32 v15, 0x10000, v14
	s_lshl_b32 s86, s26, 3
	s_lshr_b32 s60, s27, 1
	s_add_u32 s86, s86, s60
	s_and_b32 s60, s86, 3
	s_lshl_b32 s87, s60, 4
	s_and_b32 s60, s27, 1
	s_lshl_b32 s60, s60, 3
	s_add_u32 s87, s87, s60
	s_lshl_b32 s60, s3, 1
	s_add_u32 s87, s87, s60
	s_lshl_b32 s87, s87, 5
	s_lshr_b32 s60, s86, 2
	s_add_u32 s87, s87, s60
	s_lshl_b32 s87, s87, 10
	s_add_u32 s61, s87, 0x8000
	v_lshlrev_b32 v62, 5, v4
	v_lshl_add_u32 v62, v5, 3, v62
	s_mov_b32 s56, s4
	s_mov_b32 s57, s5
	s_mov_b32 s58, 0x200000
	s_mov_b32 s59, 0x20000
	buffer_load_dwordx2 v[64:65], v62, s[56:59], s87 offen
	buffer_load_dwordx2 v[66:67], v62, s[56:59], s87 offen offset:512
	buffer_load_dwordx2 v[68:69], v62, s[56:59], s61 offen
	buffer_load_dwordx2 v[70:71], v62, s[56:59], s61 offen offset:512
	v_lshrrev_b32 v2, 2, v1
	v_lshlrev_b32 v63, 7, v2
	v_bfe_u32 v2, v1, 1, 1
	v_lshl_add_u32 v63, v2, 6, v63
	v_and_b32 v2, 1, v1
	v_lshl_add_u32 v63, v2, 4, v63
	s_lshl_b32 s86, s26, 3
	s_lshr_b32 s60, s27, 1
	s_add_u32 s86, s86, s60
	s_lshl_b32 s86, s86, 14
	s_lshl_b32 s60, s3, 12
	s_add_u32 s86, s86, s60
	s_and_b32 s60, s27, 1
	s_lshl_b32 s60, s60, 5
	s_add_u32 s86, s86, s60
	s_add_u32 s52, s24, 0x410000
	s_addc_u32 s53, s25, 0
	s_mov_b32 s54, 0x200000
	s_mov_b32 s55, 0x20000
	v_mul_f32 v27, 0x3e000000, v26
	v_mul_f32 v28, 0x3d000000, v24
	v_cos_f32 v30, v27
	v_sin_f32 v34, v27
	v_add_f32 v27, v27, v28
	v_cos_f32 v31, v27
	v_sin_f32 v35, v27
	v_add_f32 v27, v27, v28
	s_add_u32 m0, s68, 0x4000
	s_nop 0
	buffer_load_dwordx4 v11, s[44:47], s63 offen lds
	s_add_u32 s63, s63, 0xe000
	v_cos_f32 v32, v27
	v_sin_f32 v36, v27
	v_add_f32 v27, v27, v28
	v_cos_f32 v33, v27
	v_sin_f32 v37, v27
	v_mul_f32 v30, 2.0, v30
	v_mul_f32 v34, -2.0, v34
	v_mul_f32 v31, 2.0, v31
	s_add_u32 m0, s68, 0x5000
	s_nop 0
	buffer_load_dwordx4 v11, s[44:47], s63 offen lds
	s_add_u32 s63, s63, 0xe000
	v_mul_f32 v35, -2.0, v35
	v_mul_f32 v32, 2.0, v32
	v_mul_f32 v36, -2.0, v36
	v_mul_f32 v33, 2.0, v33
	v_mul_f32 v37, -2.0, v37
	v_cndmask_b32 v30, v30, 1.0, s[82:83]
	v_cndmask_b32 v34, v34, v29, s[82:83]
	v_cvt_pk_bf16_f32 v72, v30, v31
	s_add_u32 m0, s68, 0x6000
	s_nop 0
	buffer_load_dwordx4 v11, s[44:47], s63 offen lds
	s_add_u32 s63, s63, 0xe000
	v_cvt_pk_bf16_f32 v74, v34, v35
	v_cvt_pk_bf16_f32 v73, v32, v33
	v_cvt_pk_bf16_f32 v75, v36, v37
	v_xor_b32 v76, 0x80000000, v72
	v_xor_b32 v77, 0x80000000, v73
	v_xor_b32 v78, 0x80000000, v74
	v_xor_b32 v79, 0x80000000, v75
	v_lshl_add_u32 v2, v5, 7, v4
	s_add_u32 m0, s68, 0x7000
	s_nop 0
	buffer_load_dwordx4 v11, s[44:47], s63 offen lds
	s_add_u32 s63, s63, 0xe000
	v_sub_u32 v3, 0x200, v2
	v_cndmask_b32 v3, v3, v2, s[80:81]
	v_add_u32 v2, 0xffffff10, v2
	s_andn2_b64 vcc, s[84:85], s[80:81]
	v_cndmask_b32 v3, v3, v2, vcc
	s_lshr_b32 s60, s3, 1
	s_lshl_b32 s60, s60, 4
	s_and_b32 s61, s3, 1
	s_lshl_b32 s61, s61, 3
	s_add_u32 s60, s60, s61
	s_add_u32 s60, s60, 0x20000
	v_lshl_add_u32 v80, v3, 5, s60
	s_or_b64 vcc, s[84:85], s[80:81]
	v_mov_b32 v2, 0xfffffc00
	v_mov_b32 v3, 0x400
	v_cndmask_b32 v2, v2, v3, vcc
	s_add_u32 m0, s68, 0x8000
	s_nop 0
	buffer_load_dwordx4 v11, s[44:47], s63 offen lds
	s_add_u32 s63, s63, 0xe000
	v_add_u32 v81, v80, v2
	v_add_u32 v82, v81, v2
	v_add_u32 v83, v82, v2
	s_lshl_b32 s60, s3, 1
	v_add_u32 v2, s60, v1
	v_and_b32 v2, 7, v2
	v_lshlrev_b32 v2, 4, v2
	v_lshl_add_u32 v84, v1, 7, v2
	v_add_u32 v84, 0x22000, v84
	s_add_u32 m0, s68, 0x9000
	s_nop 0
	buffer_load_dwordx4 v11, s[44:47], s63 offen lds
	s_add_u32 s63, s63, 0xe000
	v_add_u32 v2, s60, v1
	v_add_u32 v2, 1, v2
	v_and_b32 v2, 7, v2
	v_lshlrev_b32 v2, 4, v2
	v_lshl_add_u32 v85, v1, 7, v2
	v_add_u32 v85, 0x22000, v85
	v_lshrrev_b32 v3, 3, v1
	v_add_u32 v2, v3, v1
	s_add_u32 m0, s68, 0xa000
	s_nop 0
	buffer_load_dwordx4 v11, s[44:47], s63 offen lds
	s_add_u32 s63, s63, 0xe000
	v_and_b32 v2, 7, v2
	v_lshlrev_b32 v2, 4, v2
	v_lshl_add_u32 v86, v3, 7, v2
	s_lshl_b32 s60, s3, 11
	s_add_u32 s60, s60, 0x22000
	v_add_u32 v86, s60, v86
	s_add_u32 s36, s24, 0x610000
	s_addc_u32 s37, s25, 0
	s_mov_b32 s38, 0x200000
	s_mov_b32 s39, 0x20000
	s_add_u32 s40, s24, 0x810000
	s_addc_u32 s41, s25, 0
	s_mov_b32 s42, 0x200000
	s_mov_b32 s43, 0x20000
	s_lshl_b32 s60, s26, 4
	s_add_u32 s60, s60, s27
	s_lshl_b32 s88, s60, 13
	s_lshl_b32 s61, s3, 11
	s_add_u32 s88, s88, s61
	s_add_u32 s89, s88, 0x400
	v_lshlrev_b32 v87, 4, v1
	s_mov_b32 s90, 0x5040100
	s_mov_b32 s91, 0x7060302
	s_add_u32 m0, s68, 0xb000
	s_nop 0
	buffer_load_dwordx4 v11, s[44:47], s63 offen lds
	s_add_u32 s63, s63, 0xe000
	s_add_u32 m0, s68, 0xc000
	s_nop 0
	buffer_load_dwordx4 v11, s[44:47], s63 offen lds
	s_add_u32 s63, s63, 0xe000
	s_add_u32 m0, s68, 0xd000
	s_nop 0
	buffer_load_dwordx4 v11, s[44:47], s63 offen lds
	s_add_u32 s63, s63, 0xe000
	s_add_u32 m0, s68, 0xe000
	s_nop 0
	buffer_load_dwordx4 v11, s[44:47], s63 offen lds
	s_add_u32 s63, s63, 0xe000
	s_add_u32 m0, s68, 0xf000
	s_nop 0
	buffer_load_dwordx4 v11, s[44:47], s63 offen lds
	s_cmp_lg_u32 s3, 0
	s_cbranch_scc1 sequential_preLN__spectral_gfnet__mixer_channel_mlp__prompt_kernel_npf
	s_waitcnt lgkmcnt(0)
	s_and_b32 s61, s2, 31
	s_lshl_b32 s61, s61, 10
	s_add_u32 s61, s61, 0x28000
	s_add_u32 s16, s6, s61
	s_addc_u32 s17, s7, 0
	s_mov_b32 s62, 0x80000
sequential_preLN__spectral_gfnet__mixer_channel_mlp__prompt_kernel_pollyf:
	s_load_dword s64, s[16:17], 0 glc
	s_load_dword s65, s[16:17], 0x80 glc
	s_load_dword s66, s[16:17], 0x100 glc
	s_load_dword s67, s[16:17], 0x180 glc
	s_load_dword s12, s[16:17], 0x200 glc
	s_load_dword s13, s[16:17], 0x280 glc
	s_load_dword s14, s[16:17], 0x300 glc
	s_load_dword s15, s[16:17], 0x380 glc
	s_waitcnt lgkmcnt(0)
	s_sub_u32 s64, s64, 1
	s_cmp_eq_u32 s64, -1
	s_cselect_b32 s64, 0, s64
	s_min_u32 s64, s64, s65
	s_min_u32 s66, s66, s67
	s_min_u32 s12, s12, s13
	s_min_u32 s14, s14, s15
	s_min_u32 s64, s64, s66
	s_min_u32 s12, s12, s14
	s_min_u32 s64, s64, s12
	s_cmp_ge_u32 s64, 16
	s_cbranch_scc1 sequential_preLN__spectral_gfnet__mixer_channel_mlp__prompt_kernel_npf
	s_sub_u32 s62, s62, 1
	s_cmp_lg_u32 s62, 0
	s_cbranch_scc1 sequential_preLN__spectral_gfnet__mixer_channel_mlp__prompt_kernel_pollyf
sequential_preLN__spectral_gfnet__mixer_channel_mlp__prompt_kernel_npf:
	s_barrier
	s_lshl_b32 s60, s3, 11
	s_add_u32 m0, s60, 0x20000
	s_nop 0
	buffer_load_dwordx4 v63, s[52:55], s86 offen sc1 lds
	s_add_u32 m0, m0, 0x400
	s_add_u32 s61, s86, 0x800
	buffer_load_dwordx4 v63, s[52:55], s61 offen sc1 lds
	s_waitcnt vmcnt(17)
	v_lshlrev_b32 v184, 16, v64
	v_and_b32 v185, 0xffff0000, v64
	v_lshlrev_b32 v186, 16, v65
	v_and_b32 v187, 0xffff0000, v65
	s_waitcnt vmcnt(16)
	v_lshlrev_b32 v188, 16, v66
	v_and_b32 v189, 0xffff0000, v66
	v_lshlrev_b32 v190, 16, v67
	v_and_b32 v191, 0xffff0000, v67
	s_waitcnt vmcnt(15)
	v_lshlrev_b32 v192, 16, v68
	v_and_b32 v193, 0xffff0000, v68
	v_lshlrev_b32 v194, 16, v69
	v_and_b32 v195, 0xffff0000, v69
	s_waitcnt vmcnt(14)
	v_lshlrev_b32 v196, 16, v70
	v_and_b32 v197, 0xffff0000, v70
	v_lshlrev_b32 v198, 16, v71
	v_and_b32 v199, 0xffff0000, v71
	s_add_u32 s69, s8, 0
	buffer_load_dwordx4 a[128:131], v12, s[32:35], s69 offen sc1
	buffer_load_dwordx4 a[132:135], v12, s[32:35], s69 offen offset:1024 sc1
	buffer_load_dwordx4 a[136:139], v12, s[32:35], s69 offen offset:2048 sc1
	buffer_load_dwordx4 a[140:143], v12, s[32:35], s69 offen offset:3072 sc1
	s_waitcnt vmcnt(4)
	s_barrier
	ds_read_b64 v[224:225], v80
	ds_read_b64 v[226:227], v81
	ds_read_b64 v[228:229], v82
	ds_read_b64 v[230:231], v83
	s_waitcnt lgkmcnt(2)
	v_perm_b32 v200, v226, v224, s90
	s_waitcnt lgkmcnt(0)
	v_perm_b32 v201, v230, v228, s90
	v_perm_b32 v202, v227, v225, s90
	v_perm_b32 v203, v231, v229, s90
	s_nop 1
	v_mfma_f32_16x16x32_bf16 v[208:211], v[200:203], v[38:41], 0
	v_mfma_f32_16x16x32_bf16 v[212:215], v[200:203], v[42:45], 0
	v_mfma_f32_16x16x32_bf16 v[216:219], v[200:203], v[46:49], 0
	s_add_u32 s69, s8, 0x1000
	buffer_load_dwordx4 a[144:147], v12, s[32:35], s69 offen sc1
	v_mfma_f32_16x16x32_bf16 v[220:223], v[200:203], v[50:53], 0
	v_perm_b32 v204, v226, v224, s91
	v_perm_b32 v205, v230, v228, s91
	v_perm_b32 v206, v227, v225, s91
	v_perm_b32 v207, v231, v229, s91
	s_nop 1
	v_mfma_f32_16x16x32_bf16 v[224:227], v[204:207], v[38:41], 0
	v_mfma_f32_16x16x32_bf16 v[228:231], v[204:207], v[42:45], 0
	v_mfma_f32_16x16x32_bf16 v[232:235], v[204:207], v[46:49], 0
	v_mfma_f32_16x16x32_bf16 v[236:239], v[204:207], v[50:53], 0
	v_mul_f32 v31, v209, v55
	v_mul_f32 v35, v213, v55
	v_fma_f32 v31, -v213, v59, v31
	buffer_load_dwordx4 a[148:151], v12, s[32:35], s69 offen offset:1024 sc1
	v_fmac_f32 v35, v209, v59
	v_mul_f32 v32, v210, v56
	v_mul_f32 v36, v214, v56
	v_fma_f32 v32, -v214, v60, v32
	v_fmac_f32 v36, v210, v60
	v_mul_f32 v33, v211, v57
	v_mul_f32 v37, v215, v57
	v_fma_f32 v33, -v215, v61, v33
	v_fmac_f32 v37, v211, v61
	v_cndmask_b32 v208, v208, v216, s[82:83]
	v_cndmask_b32 v212, v212, v220, s[82:83]
	v_mul_f32 v30, v208, v54
	buffer_load_dwordx4 a[152:155], v12, s[32:35], s69 offen offset:2048 sc1
	v_mul_f32 v34, v212, v54
	v_fma_f32 v30, -v212, v58, v30
	v_fmac_f32 v34, v208, v58
	v_cvt_pk_bf16_f32 v200, v30, v31
	v_cvt_pk_bf16_f32 v201, v32, v33
	v_cvt_pk_bf16_f32 v202, v34, v35
	v_cvt_pk_bf16_f32 v203, v36, v37
	s_nop 1
	v_mfma_f32_16x16x32_bf16 v[184:187], v[200:203], v[72:75], v[184:187]
	v_mfma_f32_16x16x32_bf16 v[188:191], v[200:203], v[76:79], v[188:191]
	v_mul_f32 v31, v225, v55
	v_mul_f32 v35, v229, v55
	v_fma_f32 v31, -v229, v59, v31
	buffer_load_dwordx4 a[156:159], v12, s[32:35], s69 offen offset:3072 sc1
	v_fmac_f32 v35, v225, v59
	v_mul_f32 v32, v226, v56
	v_mul_f32 v36, v230, v56
	v_fma_f32 v32, -v230, v60, v32
	v_fmac_f32 v36, v226, v60
	v_mul_f32 v33, v227, v57
	v_mul_f32 v37, v231, v57
	v_fma_f32 v33, -v231, v61, v33
	v_fmac_f32 v37, v227, v61
	v_cndmask_b32 v224, v224, v232, s[82:83]
	v_cndmask_b32 v228, v228, v236, s[82:83]
	v_mul_f32 v30, v224, v54
	s_add_u32 s69, s8, 0x2000
	buffer_load_dwordx4 a[160:163], v12, s[32:35], s69 offen sc1
	v_mul_f32 v34, v228, v54
	v_fma_f32 v30, -v228, v58, v30
	v_fmac_f32 v34, v224, v58
	v_cvt_pk_bf16_f32 v204, v30, v31
	v_cvt_pk_bf16_f32 v205, v32, v33
	v_cvt_pk_bf16_f32 v206, v34, v35
	v_cvt_pk_bf16_f32 v207, v36, v37
	s_nop 1
	v_mfma_f32_16x16x32_bf16 v[192:195], v[204:207], v[72:75], v[192:195]
	v_mfma_f32_16x16x32_bf16 v[196:199], v[204:207], v[76:79], v[196:199]
	v_mov_b32 v224, 0x3f803f80
	v_cvt_pk_bf16_f32 v64, v184, v185
	v_cvt_pk_bf16_f32 v65, v186, v187
	buffer_load_dwordx4 a[164:167], v12, s[32:35], s69 offen offset:1024 sc1
	v_cvt_pk_bf16_f32 v66, v188, v189
	v_cvt_pk_bf16_f32 v67, v190, v191
	s_nop 0
	v_cvt_pk_bf16_f32 v68, v192, v193
	v_cvt_pk_bf16_f32 v69, v194, v195
	v_cvt_pk_bf16_f32 v70, v196, v197
	v_cvt_pk_bf16_f32 v71, v198, v199
	v_dot2_f32_bf16 v225, v64, v224, 0
	v_dot2_f32_bf16 v226, v64, v64, 0
	v_dot2_f32_bf16 v227, v68, v224, 0
	v_dot2_f32_bf16 v228, v68, v68, 0
	v_dot2_f32_bf16 v225, v65, v224, v225
	v_dot2_f32_bf16 v226, v65, v65, v226
	buffer_load_dwordx4 a[168:171], v12, s[32:35], s69 offen offset:2048 sc1
	v_dot2_f32_bf16 v227, v69, v224, v227
	v_dot2_f32_bf16 v228, v69, v69, v228
	v_dot2_f32_bf16 v225, v66, v224, v225
	v_dot2_f32_bf16 v226, v66, v66, v226
	v_dot2_f32_bf16 v227, v70, v224, v227
	v_dot2_f32_bf16 v228, v70, v70, v228
	v_dot2_f32_bf16 v225, v67, v224, v225
	v_dot2_f32_bf16 v226, v67, v67, v226
	v_dot2_f32_bf16 v227, v71, v224, v227
	v_dot2_f32_bf16 v228, v71, v71, v228
	s_nop 2
	v_permlane32_swap_b32 v225, v227
	v_permlane32_swap_b32 v226, v228
	buffer_load_dwordx4 a[172:175], v12, s[32:35], s69 offen offset:3072 sc1
	v_add_f32 v225, v225, v227
	v_add_f32 v226, v226, v228
	s_nop 1
	v_permlane16_swap_b32 v225, v226
	v_add_f32 v225, v225, v226
	s_nop 1
	v_add_f32_dpp v225, v225, v225 row_ror:1 row_mask:0xf bank_mask:0xf
	s_nop 1
	v_add_f32_dpp v225, v225, v225 row_ror:2 row_mask:0xf bank_mask:0xf
	s_nop 1
	v_add_f32_dpp v225, v225, v225 row_ror:4 row_mask:0xf bank_mask:0xf
	s_nop 1
	v_add_f32_dpp v225, v225, v225 row_ror:8 row_mask:0xf bank_mask:0xf
	v_mov_b32 v226, v225
	s_nop 1
	v_permlane16_swap_b32 v225, v226
	v_mul_f32 v225, 0x3b000000, v225
	v_mul_f32 v226, 0x3b000000, v226
	s_add_u32 s69, s8, 0x3000
	buffer_load_dwordx4 a[176:179], v12, s[32:35], s69 offen sc1
	v_fma_f32 v226, -v225, v225, v226
	v_max_f32 v226, 0, v226
	v_cvt_pk_bf16_f32 v229, v225, v225
	v_lshlrev_b32 v229, 16, v229
	v_cvt_pk_bf16_f32 v230, v226, v226
	v_lshlrev_b32 v230, 16, v230
	v_add_f32 v230, 0x3727c5ac, v230
	v_cvt_pk_bf16_f32 v230, v230, v230
	v_lshlrev_b32 v230, 16, v230
	v_sqrt_f32 v230, v230
	s_nop 0
	v_cvt_pk_bf16_f32 v230, v230, v230
	v_lshlrev_b32 v230, 16, v230
	buffer_load_dwordx4 a[180:183], v12, s[32:35], s69 offen offset:1024 sc1
	v_rcp_f32 v230, v230
	v_sub_f32 v231, v225, v229
	v_mul_f32 v231, v231, v230
	v_cvt_pk_bf16_f32 v231, v231, v231
	v_lshlrev_b32 v231, 16, v231
	v_mul_f32 v226, v226, v230
	v_mul_f32 v226, v226, v230
	v_cvt_pk_bf16_f32 v227, v226, v226
	v_lshlrev_b32 v227, 16, v227
	v_add_f32 v227, 0x3727c5ac, v227
	v_cvt_pk_bf16_f32 v227, v227, v227
	v_lshlrev_b32 v227, 16, v227
	buffer_load_dwordx4 a[184:187], v12, s[32:35], s69 offen offset:2048 sc1
	v_sqrt_f32 v227, v227
	s_nop 0
	v_cvt_pk_bf16_f32 v227, v227, v227
	v_lshlrev_b32 v227, 16, v227
	v_rcp_f32 v227, v227
	v_fmac_f32 v231, v229, v230
	v_mul_f32 v231, v231, v227
	v_mul_f32 v230, v230, v227
	v_mov_b32 v2, v230
	v_mov_b32 v3, v231
	s_nop 0
	v_permlane32_swap_b32 v230, v2
	v_permlane32_swap_b32 v231, v3
	v_fma_f32 v184, v184, v230, -v231
	buffer_load_dwordx4 a[188:191], v12, s[32:35], s69 offen offset:3072 sc1
	v_fma_f32 v185, v185, v230, -v231
	v_fma_f32 v186, v186, v230, -v231
	v_fma_f32 v187, v187, v230, -v231
	v_fma_f32 v188, v188, v230, -v231
	v_fma_f32 v189, v189, v230, -v231
	v_fma_f32 v190, v190, v230, -v231
	v_fma_f32 v191, v191, v230, -v231
	v_cvt_pk_bf16_f32 v200, v184, v185
	v_cvt_pk_bf16_f32 v201, v186, v187
	v_cvt_pk_bf16_f32 v202, v188, v189
	v_cvt_pk_bf16_f32 v203, v190, v191
	ds_write_b128 v84, v[200:203]
	v_fma_f32 v192, v192, v2, -v3
	s_add_u32 s69, s8, 0x4000
	buffer_load_dwordx4 a[192:195], v12, s[32:35], s69 offen sc1
	v_fma_f32 v193, v193, v2, -v3
	v_fma_f32 v194, v194, v2, -v3
	v_fma_f32 v195, v195, v2, -v3
	v_fma_f32 v196, v196, v2, -v3
	v_fma_f32 v197, v197, v2, -v3
	v_fma_f32 v198, v198, v2, -v3
	v_fma_f32 v199, v199, v2, -v3
	v_cvt_pk_bf16_f32 v204, v192, v193
	v_cvt_pk_bf16_f32 v205, v194, v195
	v_cvt_pk_bf16_f32 v206, v196, v197
	v_cvt_pk_bf16_f32 v207, v198, v199
	ds_write_b128 v85, v[204:207]
	s_waitcnt lgkmcnt(0)
	s_barrier
	ds_read_b128 v[208:211], v86
	ds_read_b128 v[212:215], v86 offset:1024
	s_waitcnt lgkmcnt(1)
	buffer_store_dwordx4 v[208:211], v87, s[40:43], s88 offen sc1
	s_waitcnt lgkmcnt(0)
	buffer_store_dwordx4 v[212:215], v87, s[40:43], s89 offen sc1
	buffer_store_dwordx2 v[64:65], v62, s[36:39], s88 offen sc1
	buffer_store_dwordx2 v[66:67], v62, s[36:39], s88 offen offset:512 sc1
	buffer_store_dwordx2 v[68:69], v62, s[36:39], s89 offen sc1
	buffer_store_dwordx2 v[70:71], v62, s[36:39], s89 offen offset:512 sc1
	ds_read_b64_tr_b16 a[0:1], v14 offset:0
	ds_read_b64_tr_b16 a[2:3], v15 offset:0
	ds_read_b64_tr_b16 a[4:5], v14 offset:8192
	ds_read_b64_tr_b16 a[6:7], v15 offset:8192
	ds_read_b64_tr_b16 a[8:9], v14 offset:16384
	ds_read_b64_tr_b16 a[10:11], v15 offset:16384
	ds_read_b64_tr_b16 a[12:13], v14 offset:24576
	ds_read_b64_tr_b16 a[14:15], v15 offset:24576
	buffer_load_dwordx4 a[196:199], v12, s[32:35], s69 offen offset:1024 sc1
	ds_read_b64_tr_b16 a[16:17], v14 offset:32768
	ds_read_b64_tr_b16 a[18:19], v15 offset:32768
	ds_read_b64_tr_b16 a[20:21], v14 offset:40960
	ds_read_b64_tr_b16 a[22:23], v15 offset:40960
	ds_read_b64_tr_b16 a[24:25], v14 offset:49152
	ds_read_b64_tr_b16 a[26:27], v15 offset:49152
	ds_read_b64_tr_b16 a[28:29], v14 offset:57344
	ds_read_b64_tr_b16 a[30:31], v15 offset:57344
	buffer_load_dwordx4 a[200:203], v12, s[32:35], s69 offen offset:2048 sc1
	ds_read_b64_tr_b16 a[32:33], v14 offset:1024
	ds_read_b64_tr_b16 a[34:35], v15 offset:1024
	ds_read_b64_tr_b16 a[36:37], v14 offset:9216
	ds_read_b64_tr_b16 a[38:39], v15 offset:9216
	ds_read_b64_tr_b16 a[40:41], v14 offset:17408
	ds_read_b64_tr_b16 a[42:43], v15 offset:17408
	ds_read_b64_tr_b16 a[44:45], v14 offset:25600
	ds_read_b64_tr_b16 a[46:47], v15 offset:25600
	buffer_load_dwordx4 a[204:207], v12, s[32:35], s69 offen offset:3072 sc1
	ds_read_b64_tr_b16 a[48:49], v14 offset:33792
	ds_read_b64_tr_b16 a[50:51], v15 offset:33792
	ds_read_b64_tr_b16 a[52:53], v14 offset:41984
	ds_read_b64_tr_b16 a[54:55], v15 offset:41984
	ds_read_b64_tr_b16 a[56:57], v14 offset:50176
	ds_read_b64_tr_b16 a[58:59], v15 offset:50176
	ds_read_b64_tr_b16 a[60:61], v14 offset:58368
	ds_read_b64_tr_b16 a[62:63], v15 offset:58368
	s_add_u32 s69, s8, 0x5000
	buffer_load_dwordx4 a[208:211], v12, s[32:35], s69 offen sc1
	ds_read_b64_tr_b16 a[64:65], v14 offset:2048
	ds_read_b64_tr_b16 a[66:67], v15 offset:2048
	ds_read_b64_tr_b16 a[68:69], v14 offset:10240
	ds_read_b64_tr_b16 a[70:71], v15 offset:10240
	ds_read_b64_tr_b16 a[72:73], v14 offset:18432
	ds_read_b64_tr_b16 a[74:75], v15 offset:18432
	ds_read_b64_tr_b16 a[76:77], v14 offset:26624
	ds_read_b64_tr_b16 a[78:79], v15 offset:26624
	buffer_load_dwordx4 a[212:215], v12, s[32:35], s69 offen offset:1024 sc1
	ds_read_b64_tr_b16 a[80:81], v14 offset:34816
	ds_read_b64_tr_b16 a[82:83], v15 offset:34816
	ds_read_b64_tr_b16 a[84:85], v14 offset:43008
	ds_read_b64_tr_b16 a[86:87], v15 offset:43008
	ds_read_b64_tr_b16 a[88:89], v14 offset:51200
	ds_read_b64_tr_b16 a[90:91], v15 offset:51200
	ds_read_b64_tr_b16 a[92:93], v14 offset:59392
	ds_read_b64_tr_b16 a[94:95], v15 offset:59392
	buffer_load_dwordx4 a[216:219], v12, s[32:35], s69 offen offset:2048 sc1
	ds_read_b64_tr_b16 a[96:97], v14 offset:3072
	ds_read_b64_tr_b16 a[98:99], v15 offset:3072
	ds_read_b64_tr_b16 a[100:101], v14 offset:11264
	ds_read_b64_tr_b16 a[102:103], v15 offset:11264
	ds_read_b64_tr_b16 a[104:105], v14 offset:19456
	ds_read_b64_tr_b16 a[106:107], v15 offset:19456
	ds_read_b64_tr_b16 a[108:109], v14 offset:27648
	ds_read_b64_tr_b16 a[110:111], v15 offset:27648
	buffer_load_dwordx4 a[220:223], v12, s[32:35], s69 offen offset:3072 sc1
	ds_read_b64_tr_b16 a[112:113], v14 offset:35840
	ds_read_b64_tr_b16 a[114:115], v15 offset:35840
	ds_read_b64_tr_b16 a[116:117], v14 offset:44032
	ds_read_b64_tr_b16 a[118:119], v15 offset:44032
	ds_read_b64_tr_b16 a[120:121], v14 offset:52224
	ds_read_b64_tr_b16 a[122:123], v15 offset:52224
	ds_read_b64_tr_b16 a[124:125], v14 offset:60416
	ds_read_b64_tr_b16 a[126:127], v15 offset:60416
	s_waitcnt vmcnt(7)
	s_barrier
	s_cmp_lg_u32 s3, 0
	s_cbranch_scc1 sequential_preLN__spectral_gfnet__mixer_channel_mlp__prompt_kernel_nosigf
	s_lshl_b32 s60, s26, 11
	s_and_b32 s61, s27, 12
	s_add_u32 s60, s60, s61
	buffer_atomic_add v9, v8, s[28:31], s60 offen sc1
sequential_preLN__spectral_gfnet__mixer_channel_mlp__prompt_kernel_nosigf:
	v_lshlrev_b32 v240, 16, v248
	v_and_b32 v241, 0xffff0000, v248
	v_lshlrev_b32 v242, 16, v249
	v_and_b32 v243, 0xffff0000, v249
	v_lshlrev_b32 v244, 16, v250
	v_and_b32 v245, 0xffff0000, v250
	v_lshlrev_b32 v246, 16, v251
	v_and_b32 v247, 0xffff0000, v251
	v_lshlrev_b32 v248, 16, v252
	v_and_b32 v249, 0xffff0000, v252
	v_lshlrev_b32 v250, 16, v253
	v_and_b32 v251, 0xffff0000, v253
	v_lshlrev_b32 v252, 16, v254
	v_and_b32 v253, 0xffff0000, v254
	v_lshlrev_b32 v254, 16, v255
	v_and_b32 v255, 0xffff0000, v255
	s_waitcnt lgkmcnt(0)
sequential_preLN__spectral_gfnet__mixer_channel_mlp__prompt_kernel_join_h:
	s_add_u32 s52, s24, 0xd90000
	s_addc_u32 s53, s25, 0
	s_mov_b32 s54, 0x700000
	s_mov_b32 s55, 0x20000
	s_and_b32 s60, s27, 7
	s_lshl_b32 s60, s60, 7
	v_lshl_add_u32 v2, v1, 10, s60
	v_mov_b32 v3, 0x10000000
	v_cmp_gt_u32 vcc, 14, v1
	s_nop 1
	v_cndmask_b32 v13, v3, v2, vcc
	s_mov_b32 s48, s18
	s_mov_b32 s49, s19
	s_mov_b32 s50, 0x400
	s_mov_b32 s51, 0x20000
	s_mov_b32 s44, s20
	s_mov_b32 s45, s21
	s_mov_b32 s46, 0x200000
	s_mov_b32 s47, 0x20000
	s_and_b32 s76, s27, 7
	s_lshl_b32 s76, s76, 7
	s_lshl_b32 s60, s3, 5
	s_add_u32 s76, s76, s60
	v_lshrrev_b32 v2, 5, v1
	v_lshlrev_b32 v10, 4, v2
	v_and_b32 v2, 31, v1
	v_lshl_add_u32 v4, v2, 10, v10
	s_lshl_b32 s80, s72, 15
	s_add_u32 s80, s80, s76
	s_add_u32 s81, s80, 0x8000
	v_bfe_u32 v2, v1, 4, 1
	v_lshl_add_u32 v5, v2, 19, v10
	v_and_b32 v2, 15, v1
	v_lshl_add_u32 v5, v2, 15, v5
	s_lshr_b32 s60, s72, 1
	s_lshl_b32 s60, s60, 10
	s_add_u32 s84, s60, s76
	s_add_u32 s85, s84, 0x100000
	s_xor_b32 s60, s3, 1
	s_mul_i32 s60, s60, 0x1800
	s_add_u32 s60, s60, 0
	v_add_u32 v16, s60, v6
	s_xor_b32 s60, s3, 2
	s_mul_i32 s60, s60, 0x1800
	s_add_u32 s60, s60, 0x800
	v_add_u32 v17, s60, v6
	s_xor_b32 s60, s3, 3
	s_mul_i32 s60, s60, 0x1800
	s_add_u32 s60, s60, 0x1000
	v_add_u32 v18, s60, v6
	s_mul_i32 s60, s3, 0x1800
	v_add_u32 v11, s60, v6
	s_cmp_ge_u32 s27, 14
	s_cbranch_scc1 sequential_preLN__spectral_gfnet__mixer_channel_mlp__prompt_kernel_nog1
	v_bfe_u32 v2, v1, 3, 2
	v_lshlrev_b32 v19, 13, v2
	v_lshrrev_b32 v2, 5, v1
	v_lshl_add_u32 v19, v2, 7, v19
	v_and_b32 v2, 7, v1
	v_lshl_add_u32 v19, v2, 4, v19
	s_and_b32 s5, s78, 1
	s_lshl_b32 s60, s5, 1
	s_xor_b32 s60, s60, 0
	s_lshl_b32 s61, s77, 2
	s_add_u32 s12, s60, s61
	s_lshl_b32 s60, s5, 1
	s_xor_b32 s60, s60, 2
	s_lshl_b32 s61, s77, 2
	s_add_u32 s13, s60, s61
	s_lshl_b32 s60, s5, 1
	s_xor_b32 s60, s60, 1
	s_lshl_b32 s61, s77, 2
	s_add_u32 s14, s60, s61
	s_lshl_b32 s60, s5, 1
	s_xor_b32 s60, s60, 3
	s_lshl_b32 s61, s77, 2
	s_add_u32 s15, s60, s61
	v_mov_b32 v20, 0xc0135761
	s_mov_b32 s10, 0xbdd2d3e8
	v_mov_b32 v21, 0xc0135761
	s_mov_b32 s11, 0xbdd2d3e8
	s_lshr_b32 s60, s78, 1
	s_mul_i32 s61, s5, 7
	s_add_u32 s61, s60, s61
	s_lshl_b32 s4, s61, 11
	s_mul_i32 s61, s3, 0x7000
	s_add_u32 s4, s4, s61
	s_lshl_b32 s68, s60, 2
	s_mov_b32 s68, 0
	s_lshl_b32 s60, s77, 4
	s_lshl_b32 s61, s5, 3
	s_add_u32 s61, s61, s60
	s_lshl_b32 s61, s61, 2
	s_add_u32 s61, s61, s3
	s_lshl_b32 s61, s61, 7
	s_add_u32 s61, s61, s68
	s_add_u32 s5, s61, 0x8000
	s_xor_b32 s68, s5, 0x1000
	s_and_b32 s61, s12, 3
	s_lshl_b32 s61, s61, 2
	s_add_u32 s61, s61, s79
	s_waitcnt lgkmcnt(0)
	s_mov_b32 s62, 0x80000
sequential_preLN__spectral_gfnet__mixer_channel_mlp__prompt_kernel_pollt0:
	s_load_dword s64, s[6:7], s61 glc
	s_waitcnt lgkmcnt(0)
	s_cmp_ge_u32 s64, 4
	s_cbranch_scc1 sequential_preLN__spectral_gfnet__mixer_channel_mlp__prompt_kernel_donet0
	s_sub_u32 s62, s62, 1
	s_cmp_lg_u32 s62, 0
	s_cbranch_scc1 sequential_preLN__spectral_gfnet__mixer_channel_mlp__prompt_kernel_pollt0
sequential_preLN__spectral_gfnet__mixer_channel_mlp__prompt_kernel_donet0:
	s_lshl_b32 s16, s12, 15
	s_lshl_b32 s60, s3, 8
	s_add_u32 s16, s16, s60
	s_lshl_b32 s17, s3, 10
	s_add_u32 s17, s17, 0x20000
	s_add_u32 m0, s17, 0
	s_add_u32 s60, s16, 0
	buffer_load_dwordx4 v19, s[40:43], s60 offen sc1 lds
	s_add_u32 m0, s17, 0x1000
	s_add_u32 s60, s16, 0x400
	buffer_load_dwordx4 v19, s[40:43], s60 offen sc1 lds
	s_add_u32 m0, s17, 0x2000
	s_add_u32 s60, s16, 0x800
	buffer_load_dwordx4 v19, s[40:43], s60 offen sc1 lds
	s_add_u32 m0, s17, 0x3000
	s_add_u32 s60, s16, 0xc00
	buffer_load_dwordx4 v19, s[40:43], s60 offen sc1 lds
	s_add_u32 m0, s17, 0x4000
	s_add_u32 s60, s16, 0x1000
	buffer_load_dwordx4 v19, s[40:43], s60 offen sc1 lds
	s_add_u32 m0, s17, 0x5000
	s_add_u32 s60, s16, 0x1400
	buffer_load_dwordx4 v19, s[40:43], s60 offen sc1 lds
	s_add_u32 m0, s17, 0x6000
	s_add_u32 s60, s16, 0x1800
	buffer_load_dwordx4 v19, s[40:43], s60 offen sc1 lds
	s_add_u32 m0, s17, 0x7000
	s_add_u32 s60, s16, 0x1c00
	buffer_load_dwordx4 v19, s[40:43], s60 offen sc1 lds
	s_barrier
	s_waitcnt lgkmcnt(0)
	s_mov_b32 s62, 0x80000
sequential_preLN__spectral_gfnet__mixer_channel_mlp__prompt_kernel_pollt1:
	s_load_dwordx4 s[64:67], s[6:7], s79 glc
	s_waitcnt lgkmcnt(0)
	s_min_u32 s64, s64, s65
	s_min_u32 s66, s66, s67
	s_min_u32 s64, s64, s66
	s_cmp_ge_u32 s64, 4
	s_cbranch_scc1 sequential_preLN__spectral_gfnet__mixer_channel_mlp__prompt_kernel_donet1
	s_sub_u32 s62, s62, 1
	s_cmp_lg_u32 s62, 0
	s_cbranch_scc1 sequential_preLN__spectral_gfnet__mixer_channel_mlp__prompt_kernel_pollt1
sequential_preLN__spectral_gfnet__mixer_channel_mlp__prompt_kernel_donet1:
	s_lshl_b32 s16, s13, 15
	s_lshl_b32 s60, s3, 8
	s_add_u32 s16, s16, s60
	s_lshl_b32 s17, s3, 10
	s_add_u32 s17, s17, 0
	s_add_u32 m0, s17, 0
	s_add_u32 s60, s16, 0
	buffer_load_dwordx4 v19, s[40:43], s60 offen sc1 lds
	s_add_u32 m0, s17, 0x1000
	s_add_u32 s60, s16, 0x400
	buffer_load_dwordx4 v19, s[40:43], s60 offen sc1 lds
	s_add_u32 m0, s17, 0x2000
	s_add_u32 s60, s16, 0x800
	buffer_load_dwordx4 v19, s[40:43], s60 offen sc1 lds
	s_add_u32 m0, s17, 0x3000
	s_add_u32 s60, s16, 0xc00
	buffer_load_dwordx4 v19, s[40:43], s60 offen sc1 lds
	s_add_u32 m0, s17, 0x4000
	s_add_u32 s60, s16, 0x1000
	buffer_load_dwordx4 v19, s[40:43], s60 offen sc1 lds
	s_add_u32 m0, s17, 0x5000
	s_add_u32 s60, s16, 0x1400
	buffer_load_dwordx4 v19, s[40:43], s60 offen sc1 lds
	s_add_u32 m0, s17, 0x6000
	s_add_u32 s60, s16, 0x1800
	buffer_load_dwordx4 v19, s[40:43], s60 offen sc1 lds
	s_add_u32 m0, s17, 0x7000
	s_add_u32 s60, s16, 0x1c00
	buffer_load_dwordx4 v19, s[40:43], s60 offen sc1 lds
	v_add_u32 v15, 0x10000, v6
	v_add_u32 v14, 0x20000, v6
	s_waitcnt vmcnt(12)
	s_barrier
	ds_read_b128 v[184:187], v14
	ds_read_b128 v[188:191], v14 offset:1024
	ds_read_b128 v[192:195], v14 offset:2048
	ds_read_b128 v[196:199], v14 offset:3072
	ds_read_b128 v[200:203], v14 offset:4096
	ds_read_b128 v[204:207], v14 offset:5120
	ds_read_b128 v[208:211], v14 offset:6144
	s_waitcnt lgkmcnt(5)
	v_mfma_f32_32x32x16_bf16 v[24:39], a[0:3], v[184:187], v[240:255]
	ds_read_b128 v[212:215], v14 offset:7168
	v_mfma_f32_32x32x16_bf16 v[24:39], a[4:7], v[188:191], v[24:39]
	s_lshl_b32 s16, s14, 15
	s_lshl_b32 s60, s3, 8
	s_add_u32 s16, s16, s60
	s_lshl_b32 s17, s3, 10
	s_add_u32 s17, s17, 0x8000
	s_add_u32 m0, s17, 0
	s_add_u32 s60, s16, 0
	buffer_load_dwordx4 v19, s[40:43], s60 offen sc1 lds
	ds_read_b128 v[184:187], v14 offset:8192
	s_waitcnt lgkmcnt(5)
	v_mfma_f32_32x32x16_bf16 v[24:39], a[8:11], v[192:195], v[24:39]
	ds_read_b128 v[188:191], v14 offset:9216
	v_mfma_f32_32x32x16_bf16 v[24:39], a[12:15], v[196:199], v[24:39]
	s_add_u32 m0, s17, 0x1000
	s_add_u32 s60, s16, 0x400
	buffer_load_dwordx4 v19, s[40:43], s60 offen sc1 lds
	ds_read_b128 v[192:195], v14 offset:10240
	s_waitcnt lgkmcnt(5)
	v_mfma_f32_32x32x16_bf16 v[24:39], a[16:19], v[200:203], v[24:39]
	ds_read_b128 v[196:199], v14 offset:11264
	v_mfma_f32_32x32x16_bf16 v[24:39], a[20:23], v[204:207], v[24:39]
	s_add_u32 m0, s17, 0x2000
	s_add_u32 s60, s16, 0x800
	buffer_load_dwordx4 v19, s[40:43], s60 offen sc1 lds
	ds_read_b128 v[200:203], v14 offset:12288
	s_waitcnt lgkmcnt(5)
	v_mfma_f32_32x32x16_bf16 v[24:39], a[24:27], v[208:211], v[24:39]
	ds_read_b128 v[204:207], v14 offset:13312
	v_mfma_f32_32x32x16_bf16 v[24:39], a[28:31], v[212:215], v[24:39]
	s_add_u32 m0, s17, 0x3000
	s_add_u32 s60, s16, 0xc00
	buffer_load_dwordx4 v19, s[40:43], s60 offen sc1 lds
	ds_read_b128 v[208:211], v14 offset:14336
	s_waitcnt lgkmcnt(5)
	v_mfma_f32_32x32x16_bf16 v[24:39], a[32:35], v[184:187], v[24:39]
	s_waitcnt vmcnt(12)
	s_barrier
	ds_read_b128 v[212:215], v14 offset:15360
	v_mfma_f32_32x32x16_bf16 v[24:39], a[36:39], v[188:191], v[24:39]
	s_add_u32 m0, s17, 0x4000
	s_add_u32 s60, s16, 0x1000
	buffer_load_dwordx4 v19, s[40:43], s60 offen sc1 lds
	ds_read_b128 v[184:187], v14 offset:16384
	s_waitcnt lgkmcnt(5)
	v_mfma_f32_32x32x16_bf16 v[24:39], a[40:43], v[192:195], v[24:39]
	ds_read_b128 v[188:191], v14 offset:17408
	v_mfma_f32_32x32x16_bf16 v[24:39], a[44:47], v[196:199], v[24:39]
	s_add_u32 m0, s17, 0x5000
	s_add_u32 s60, s16, 0x1400
	buffer_load_dwordx4 v19, s[40:43], s60 offen sc1 lds
	ds_read_b128 v[192:195], v14 offset:18432
	s_waitcnt lgkmcnt(5)
	v_mfma_f32_32x32x16_bf16 v[24:39], a[48:51], v[200:203], v[24:39]
	ds_read_b128 v[196:199], v14 offset:19456
	v_mfma_f32_32x32x16_bf16 v[24:39], a[52:55], v[204:207], v[24:39]
	s_add_u32 m0, s17, 0x6000
	s_add_u32 s60, s16, 0x1800
	buffer_load_dwordx4 v19, s[40:43], s60 offen sc1 lds
	ds_read_b128 v[200:203], v14 offset:20480
	s_waitcnt lgkmcnt(5)
	v_mfma_f32_32x32x16_bf16 v[24:39], a[56:59], v[208:211], v[24:39]
	ds_read_b128 v[204:207], v14 offset:21504
	v_mfma_f32_32x32x16_bf16 v[24:39], a[60:63], v[212:215], v[24:39]
	s_add_u32 m0, s17, 0x7000
	s_add_u32 s60, s16, 0x1c00
	buffer_load_dwordx4 v19, s[40:43], s60 offen sc1 lds
	ds_read_b128 v[208:211], v14 offset:22528
	s_waitcnt lgkmcnt(5)
	v_mfma_f32_32x32x16_bf16 v[24:39], a[64:67], v[184:187], v[24:39]
	ds_read_b128 v[212:215], v14 offset:23552
	v_mfma_f32_32x32x16_bf16 v[24:39], a[68:71], v[188:191], v[24:39]
	s_add_u32 s69, s8, 0x6000
	buffer_load_dwordx4 a[224:227], v12, s[32:35], s69 offen sc1
	ds_read_b128 v[184:187], v14 offset:24576
	s_waitcnt lgkmcnt(5)
	v_mfma_f32_32x32x16_bf16 v[24:39], a[72:75], v[192:195], v[24:39]
	ds_read_b128 v[188:191], v14 offset:25600
	v_mfma_f32_32x32x16_bf16 v[24:39], a[76:79], v[196:199], v[24:39]
	buffer_load_dwordx4 a[228:231], v12, s[32:35], s69 offen offset:1024 sc1
	ds_read_b128 v[192:195], v14 offset:26624
	s_waitcnt lgkmcnt(5)
	v_mfma_f32_32x32x16_bf16 v[24:39], a[80:83], v[200:203], v[24:39]
	ds_read_b128 v[196:199], v14 offset:27648
	v_mfma_f32_32x32x16_bf16 v[24:39], a[84:87], v[204:207], v[24:39]
	buffer_load_dwordx4 a[232:235], v12, s[32:35], s69 offen offset:2048 sc1
	ds_read_b128 v[200:203], v14 offset:28672
	s_waitcnt lgkmcnt(5)
	v_mfma_f32_32x32x16_bf16 v[24:39], a[88:91], v[208:211], v[24:39]
	ds_read_b128 v[204:207], v14 offset:29696
	v_mfma_f32_32x32x16_bf16 v[24:39], a[92:95], v[212:215], v[24:39]
	buffer_load_dwordx4 a[236:239], v12, s[32:35], s69 offen offset:3072 sc1
	s_waitcnt vmcnt(12)
	s_barrier
	ds_read_b128 v[208:211], v14 offset:30720
	s_waitcnt lgkmcnt(5)
	v_mfma_f32_32x32x16_bf16 v[24:39], a[96:99], v[184:187], v[24:39]
	ds_read_b128 v[212:215], v14 offset:31744
	v_mfma_f32_32x32x16_bf16 v[24:39], a[100:103], v[188:191], v[24:39]
	s_add_u32 s69, s9, 0
	buffer_load_dwordx4 a[240:243], v12, s[32:35], s69 offen sc1
	ds_read_b128 v[184:187], v6
	s_waitcnt lgkmcnt(5)
	v_mfma_f32_32x32x16_bf16 v[24:39], a[104:107], v[192:195], v[24:39]
	ds_read_b128 v[188:191], v6 offset:1024
	v_mfma_f32_32x32x16_bf16 v[24:39], a[108:111], v[196:199], v[24:39]
	buffer_load_dwordx4 a[244:247], v12, s[32:35], s69 offen offset:1024 sc1
	ds_read_b128 v[192:195], v6 offset:2048
	s_waitcnt lgkmcnt(5)
	v_mfma_f32_32x32x16_bf16 v[24:39], a[112:115], v[200:203], v[24:39]
	ds_read_b128 v[196:199], v6 offset:3072
	v_mfma_f32_32x32x16_bf16 v[24:39], a[116:119], v[204:207], v[24:39]
	buffer_load_dwordx4 a[248:251], v12, s[32:35], s69 offen offset:2048 sc1
	ds_read_b128 v[200:203], v6 offset:4096
	s_waitcnt lgkmcnt(5)
	v_mfma_f32_32x32x16_bf16 v[24:39], a[120:123], v[208:211], v[24:39]
	ds_read_b128 v[204:207], v6 offset:5120
	v_mfma_f32_32x32x16_bf16 v[24:39], a[124:127], v[212:215], v[24:39]
	buffer_load_dwordx4 a[252:255], v12, s[32:35], s69 offen offset:3072 sc1
	s_nop 10
	v_pk_mul_f32 v[216:217], v[24:25], v[24:25]
	v_pk_mul_f32 v[218:219], v[26:27], v[26:27]
	v_pk_mul_f32 v[220:221], v[28:29], v[28:29]
	v_pk_mul_f32 v[222:223], v[30:31], v[30:31]
	v_pk_mul_f32 v[224:225], v[32:33], v[32:33]
	v_pk_mul_f32 v[226:227], v[34:35], v[34:35]
	v_pk_mul_f32 v[228:229], v[36:37], v[36:37]
	v_pk_mul_f32 v[230:231], v[38:39], v[38:39]
	v_pk_fma_f32 v[216:217], v[216:217], s[10:11], v[20:21]
	v_pk_fma_f32 v[218:219], v[218:219], s[10:11], v[20:21]
	v_pk_fma_f32 v[220:221], v[220:221], s[10:11], v[20:21]
	v_pk_fma_f32 v[222:223], v[222:223], s[10:11], v[20:21]
	v_pk_fma_f32 v[224:225], v[224:225], s[10:11], v[20:21]
	v_pk_fma_f32 v[226:227], v[226:227], s[10:11], v[20:21]
	v_pk_fma_f32 v[228:229], v[228:229], s[10:11], v[20:21]
	v_pk_fma_f32 v[230:231], v[230:231], s[10:11], v[20:21]
	v_pk_mul_f32 v[216:217], v[216:217], v[24:25]
	v_pk_mul_f32 v[218:219], v[218:219], v[26:27]
	v_pk_mul_f32 v[220:221], v[220:221], v[28:29]
	v_pk_mul_f32 v[222:223], v[222:223], v[30:31]
	v_pk_mul_f32 v[224:225], v[224:225], v[32:33]
	v_pk_mul_f32 v[226:227], v[226:227], v[34:35]
	v_pk_mul_f32 v[228:229], v[228:229], v[36:37]
	s_add_u32 s69, s9, 0x1000
	buffer_load_dwordx4 v[88:91], v12, s[32:35], s69 offen sc1
	v_pk_mul_f32 v[230:231], v[230:231], v[38:39]
	v_exp_f32 v216, v216
	v_exp_f32 v217, v217
	v_exp_f32 v218, v218
	v_exp_f32 v219, v219
	v_exp_f32 v220, v220
	v_exp_f32 v221, v221
	v_exp_f32 v222, v222
	v_exp_f32 v223, v223
	v_exp_f32 v224, v224
	v_exp_f32 v225, v225
	v_exp_f32 v226, v226
	v_exp_f32 v227, v227
	v_exp_f32 v228, v228
	v_exp_f32 v229, v229
	v_exp_f32 v230, v230
	v_exp_f32 v231, v231
	v_pk_add_f32 v[216:217], v[216:217], 1.0 op_sel_hi:[1,0]
	v_pk_add_f32 v[218:219], v[218:219], 1.0 op_sel_hi:[1,0]
	v_pk_add_f32 v[220:221], v[220:221], 1.0 op_sel_hi:[1,0]
	v_pk_add_f32 v[222:223], v[222:223], 1.0 op_sel_hi:[1,0]
	v_pk_add_f32 v[224:225], v[224:225], 1.0 op_sel_hi:[1,0]
	v_pk_add_f32 v[226:227], v[226:227], 1.0 op_sel_hi:[1,0]
	v_pk_add_f32 v[228:229], v[228:229], 1.0 op_sel_hi:[1,0]
	buffer_load_dwordx4 v[92:95], v12, s[32:35], s69 offen offset:1024 sc1
	v_pk_add_f32 v[230:231], v[230:231], 1.0 op_sel_hi:[1,0]
	v_rcp_f32 v216, v216
	v_rcp_f32 v217, v217
	v_rcp_f32 v218, v218
	v_rcp_f32 v219, v219
	v_rcp_f32 v220, v220
	v_rcp_f32 v221, v221
	v_rcp_f32 v222, v222
	v_rcp_f32 v223, v223
	v_rcp_f32 v224, v224
	v_rcp_f32 v225, v225
	v_rcp_f32 v226, v226
	v_rcp_f32 v227, v227
	v_rcp_f32 v228, v228
	v_rcp_f32 v229, v229
	v_rcp_f32 v230, v230
	v_rcp_f32 v231, v231
	v_pk_mul_f32 v[216:217], v[216:217], v[24:25]
	v_pk_mul_f32 v[218:219], v[218:219], v[26:27]
	v_pk_mul_f32 v[220:221], v[220:221], v[28:29]
	v_pk_mul_f32 v[222:223], v[222:223], v[30:31]
	v_pk_mul_f32 v[224:225], v[224:225], v[32:33]
	v_pk_mul_f32 v[226:227], v[226:227], v[34:35]
	v_pk_mul_f32 v[228:229], v[228:229], v[36:37]
	buffer_load_dwordx4 v[96:99], v12, s[32:35], s69 offen offset:2048 sc1
	v_pk_mul_f32 v[230:231], v[230:231], v[38:39]
	v_cvt_pk_bf16_f32 v232, v216, v217
	v_cvt_pk_bf16_f32 v233, v218, v219
	v_cvt_pk_bf16_f32 v234, v220, v221
	v_cvt_pk_bf16_f32 v235, v222, v223
	v_cvt_pk_bf16_f32 v236, v224, v225
	v_cvt_pk_bf16_f32 v237, v226, v227
	v_cvt_pk_bf16_f32 v238, v228, v229
	v_cvt_pk_bf16_f32 v239, v230, v231
	s_mul_i32 s63, s12, 0x1c000
	s_add_u32 s63, s63, s4
	buffer_store_dwordx4 v[232:235], v6, s[52:55], s63 offen sc1
	buffer_store_dwordx4 v[236:239], v6, s[52:55], s63 offen offset:1024 sc1
	ds_read_b128 v[208:211], v6 offset:6144
	s_waitcnt lgkmcnt(5)
	v_mfma_f32_32x32x16_bf16 v[56:71], a[0:3], v[184:187], v[240:255]
	ds_read_b128 v[212:215], v6 offset:7168
	v_mfma_f32_32x32x16_bf16 v[56:71], a[4:7], v[188:191], v[56:71]
	s_lshl_b32 s16, s15, 15
	s_lshl_b32 s60, s3, 8
	s_add_u32 s16, s16, s60
	s_lshl_b32 s17, s3, 10
	s_add_u32 s17, s17, 0x10000
	s_add_u32 m0, s17, 0
	s_add_u32 s60, s16, 0
	buffer_load_dwordx4 v19, s[40:43], s60 offen sc1 lds
	ds_read_b128 v[184:187], v6 offset:8192
	s_waitcnt lgkmcnt(5)
	v_mfma_f32_32x32x16_bf16 v[56:71], a[8:11], v[192:195], v[56:71]
	ds_read_b128 v[188:191], v6 offset:9216
	v_mfma_f32_32x32x16_bf16 v[56:71], a[12:15], v[196:199], v[56:71]
	s_add_u32 m0, s17, 0x1000
	s_add_u32 s60, s16, 0x400
	buffer_load_dwordx4 v19, s[40:43], s60 offen sc1 lds
	ds_read_b128 v[192:195], v6 offset:10240
	s_waitcnt lgkmcnt(5)
	v_mfma_f32_32x32x16_bf16 v[56:71], a[16:19], v[200:203], v[56:71]
	ds_read_b128 v[196:199], v6 offset:11264
	v_mfma_f32_32x32x16_bf16 v[56:71], a[20:23], v[204:207], v[56:71]
	s_add_u32 m0, s17, 0x2000
	s_add_u32 s60, s16, 0x800
	buffer_load_dwordx4 v19, s[40:43], s60 offen sc1 lds
	ds_read_b128 v[200:203], v6 offset:12288
	s_waitcnt lgkmcnt(5)
	v_mfma_f32_32x32x16_bf16 v[56:71], a[24:27], v[208:211], v[56:71]
	ds_read_b128 v[204:207], v6 offset:13312
	v_mfma_f32_32x32x16_bf16 v[56:71], a[28:31], v[212:215], v[56:71]
	s_add_u32 m0, s17, 0x3000
	s_add_u32 s60, s16, 0xc00
	buffer_load_dwordx4 v19, s[40:43], s60 offen sc1 lds
	ds_read_b128 v[208:211], v6 offset:14336
	s_waitcnt lgkmcnt(5)
	v_mfma_f32_32x32x16_bf16 v[56:71], a[32:35], v[184:187], v[56:71]
	ds_read_b128 v[212:215], v6 offset:15360
	v_mfma_f32_32x32x16_bf16 v[56:71], a[36:39], v[188:191], v[56:71]
	s_add_u32 m0, s17, 0x4000
	s_add_u32 s60, s16, 0x1000
	buffer_load_dwordx4 v19, s[40:43], s60 offen sc1 lds
	ds_read_b128 v[184:187], v6 offset:16384
	s_waitcnt lgkmcnt(5)
	v_mfma_f32_32x32x16_bf16 v[56:71], a[40:43], v[192:195], v[56:71]
	ds_read_b128 v[188:191], v6 offset:17408
	v_mfma_f32_32x32x16_bf16 v[56:71], a[44:47], v[196:199], v[56:71]
	s_add_u32 m0, s17, 0x5000
	s_add_u32 s60, s16, 0x1400
	buffer_load_dwordx4 v19, s[40:43], s60 offen sc1 lds
	ds_read_b128 v[192:195], v6 offset:18432
	s_waitcnt lgkmcnt(5)
	v_mfma_f32_32x32x16_bf16 v[56:71], a[48:51], v[200:203], v[56:71]
	ds_read_b128 v[196:199], v6 offset:19456
	v_mfma_f32_32x32x16_bf16 v[56:71], a[52:55], v[204:207], v[56:71]
	s_add_u32 m0, s17, 0x6000
	s_add_u32 s60, s16, 0x1800
	buffer_load_dwordx4 v19, s[40:43], s60 offen sc1 lds
	ds_read_b128 v[200:203], v6 offset:20480
	s_waitcnt lgkmcnt(5)
	v_mfma_f32_32x32x16_bf16 v[56:71], a[56:59], v[208:211], v[56:71]
	ds_read_b128 v[204:207], v6 offset:21504
	v_mfma_f32_32x32x16_bf16 v[56:71], a[60:63], v[212:215], v[56:71]
	s_add_u32 m0, s17, 0x7000
	s_add_u32 s60, s16, 0x1c00
	buffer_load_dwordx4 v19, s[40:43], s60 offen sc1 lds
	ds_read_b128 v[208:211], v6 offset:22528
	s_waitcnt lgkmcnt(5)
	v_mfma_f32_32x32x16_bf16 v[56:71], a[64:67], v[184:187], v[56:71]
	ds_read_b128 v[212:215], v6 offset:23552
	v_mfma_f32_32x32x16_bf16 v[56:71], a[68:71], v[188:191], v[56:71]
	buffer_load_dwordx4 v[100:103], v12, s[32:35], s69 offen offset:3072 sc1
	ds_read_b128 v[184:187], v6 offset:24576
	s_waitcnt lgkmcnt(5)
	v_mfma_f32_32x32x16_bf16 v[56:71], a[72:75], v[192:195], v[56:71]
	ds_read_b128 v[188:191], v6 offset:25600
	v_mfma_f32_32x32x16_bf16 v[56:71], a[76:79], v[196:199], v[56:71]
	s_add_u32 s69, s9, 0x2000
	buffer_load_dwordx4 v[104:107], v12, s[32:35], s69 offen sc1
	ds_read_b128 v[192:195], v6 offset:26624
	s_waitcnt lgkmcnt(5)
	v_mfma_f32_32x32x16_bf16 v[56:71], a[80:83], v[200:203], v[56:71]
	ds_read_b128 v[196:199], v6 offset:27648
	v_mfma_f32_32x32x16_bf16 v[56:71], a[84:87], v[204:207], v[56:71]
	buffer_load_dwordx4 v[108:111], v12, s[32:35], s69 offen offset:1024 sc1
	ds_read_b128 v[200:203], v6 offset:28672
	s_waitcnt lgkmcnt(5)
	v_mfma_f32_32x32x16_bf16 v[56:71], a[88:91], v[208:211], v[56:71]
	ds_read_b128 v[204:207], v6 offset:29696
	v_mfma_f32_32x32x16_bf16 v[56:71], a[92:95], v[212:215], v[56:71]
	buffer_load_dwordx4 v[112:115], v12, s[32:35], s69 offen offset:2048 sc1
	s_waitcnt vmcnt(25)
	s_barrier
	ds_read_b128 v[208:211], v6 offset:30720
	s_waitcnt lgkmcnt(5)
	v_mfma_f32_32x32x16_bf16 v[56:71], a[96:99], v[184:187], v[56:71]
	ds_read_b128 v[212:215], v6 offset:31744
	v_mfma_f32_32x32x16_bf16 v[56:71], a[100:103], v[188:191], v[56:71]
	buffer_load_dwordx4 v[116:119], v12, s[32:35], s69 offen offset:3072 sc1
	ds_read_b128 v[184:187], v6 offset:32768
	s_waitcnt lgkmcnt(5)
	v_mfma_f32_32x32x16_bf16 v[56:71], a[104:107], v[192:195], v[56:71]
	s_waitcnt vmcnt(13)
	buffer_atomic_add v9, v7, s[28:31], s5 offen offset:0 sc1
	ds_read_b128 v[188:191], v6 offset:33792
	v_mfma_f32_32x32x16_bf16 v[56:71], a[108:111], v[196:199], v[56:71]
	s_add_u32 s69, s9, 0x3000
	buffer_load_dwordx4 v[120:123], v12, s[32:35], s69 offen sc1
	ds_read_b128 v[192:195], v6 offset:34816
	s_waitcnt lgkmcnt(5)
	v_mfma_f32_32x32x16_bf16 v[56:71], a[112:115], v[200:203], v[56:71]
	ds_read_b128 v[196:199], v6 offset:35840
	v_mfma_f32_32x32x16_bf16 v[56:71], a[116:119], v[204:207], v[56:71]
	buffer_load_dwordx4 v[124:127], v12, s[32:35], s69 offen offset:1024 sc1
	ds_read_b128 v[200:203], v6 offset:36864
	s_waitcnt lgkmcnt(5)
	v_mfma_f32_32x32x16_bf16 v[56:71], a[120:123], v[208:211], v[56:71]
	ds_read_b128 v[204:207], v6 offset:37888
	v_mfma_f32_32x32x16_bf16 v[56:71], a[124:127], v[212:215], v[56:71]
	buffer_load_dwordx4 v[128:131], v12, s[32:35], s69 offen offset:2048 sc1
	s_nop 10
	v_pk_mul_f32 v[216:217], v[56:57], v[56:57]
	v_pk_mul_f32 v[218:219], v[58:59], v[58:59]
	v_pk_mul_f32 v[220:221], v[60:61], v[60:61]
	v_pk_mul_f32 v[222:223], v[62:63], v[62:63]
	v_pk_mul_f32 v[224:225], v[64:65], v[64:65]
	v_pk_mul_f32 v[226:227], v[66:67], v[66:67]
	v_pk_mul_f32 v[228:229], v[68:69], v[68:69]
	v_pk_mul_f32 v[230:231], v[70:71], v[70:71]
	v_pk_fma_f32 v[216:217], v[216:217], s[10:11], v[20:21]
	v_pk_fma_f32 v[218:219], v[218:219], s[10:11], v[20:21]
	v_pk_fma_f32 v[220:221], v[220:221], s[10:11], v[20:21]
	v_pk_fma_f32 v[222:223], v[222:223], s[10:11], v[20:21]
	v_pk_fma_f32 v[224:225], v[224:225], s[10:11], v[20:21]
	v_pk_fma_f32 v[226:227], v[226:227], s[10:11], v[20:21]
	v_pk_fma_f32 v[228:229], v[228:229], s[10:11], v[20:21]
	v_pk_fma_f32 v[230:231], v[230:231], s[10:11], v[20:21]
	v_pk_mul_f32 v[216:217], v[216:217], v[56:57]
	v_pk_mul_f32 v[218:219], v[218:219], v[58:59]
	v_pk_mul_f32 v[220:221], v[220:221], v[60:61]
	v_pk_mul_f32 v[222:223], v[222:223], v[62:63]
	v_pk_mul_f32 v[224:225], v[224:225], v[64:65]
	v_pk_mul_f32 v[226:227], v[226:227], v[66:67]
	v_pk_mul_f32 v[228:229], v[228:229], v[68:69]
	buffer_load_dwordx4 v[132:135], v12, s[32:35], s69 offen offset:3072 sc1
	v_pk_mul_f32 v[230:231], v[230:231], v[70:71]
	v_exp_f32 v216, v216
	v_exp_f32 v217, v217
	v_exp_f32 v218, v218
	v_exp_f32 v219, v219
	v_exp_f32 v220, v220
	v_exp_f32 v221, v221
	v_exp_f32 v222, v222
	v_exp_f32 v223, v223
	v_exp_f32 v224, v224
	v_exp_f32 v225, v225
	v_exp_f32 v226, v226
	v_exp_f32 v227, v227
	v_exp_f32 v228, v228
	v_exp_f32 v229, v229
	v_exp_f32 v230, v230
	v_exp_f32 v231, v231
	v_pk_add_f32 v[216:217], v[216:217], 1.0 op_sel_hi:[1,0]
	v_pk_add_f32 v[218:219], v[218:219], 1.0 op_sel_hi:[1,0]
	v_pk_add_f32 v[220:221], v[220:221], 1.0 op_sel_hi:[1,0]
	v_pk_add_f32 v[222:223], v[222:223], 1.0 op_sel_hi:[1,0]
	v_pk_add_f32 v[224:225], v[224:225], 1.0 op_sel_hi:[1,0]
	v_pk_add_f32 v[226:227], v[226:227], 1.0 op_sel_hi:[1,0]
	v_pk_add_f32 v[228:229], v[228:229], 1.0 op_sel_hi:[1,0]
	s_add_u32 s69, s9, 0x4000
	buffer_load_dwordx4 v[136:139], v12, s[32:35], s69 offen sc1
	v_pk_add_f32 v[230:231], v[230:231], 1.0 op_sel_hi:[1,0]
	v_rcp_f32 v216, v216
	v_rcp_f32 v217, v217
	v_rcp_f32 v218, v218
	v_rcp_f32 v219, v219
	v_rcp_f32 v220, v220
	v_rcp_f32 v221, v221
	v_rcp_f32 v222, v222
	v_rcp_f32 v223, v223
	v_rcp_f32 v224, v224
	v_rcp_f32 v225, v225
	v_rcp_f32 v226, v226
	v_rcp_f32 v227, v227
	v_rcp_f32 v228, v228
	v_rcp_f32 v229, v229
	v_rcp_f32 v230, v230
	v_rcp_f32 v231, v231
	v_pk_mul_f32 v[216:217], v[216:217], v[56:57]
	v_pk_mul_f32 v[218:219], v[218:219], v[58:59]
	v_pk_mul_f32 v[220:221], v[220:221], v[60:61]
	v_pk_mul_f32 v[222:223], v[222:223], v[62:63]
	v_pk_mul_f32 v[224:225], v[224:225], v[64:65]
	v_pk_mul_f32 v[226:227], v[226:227], v[66:67]
	v_pk_mul_f32 v[228:229], v[228:229], v[68:69]
	buffer_load_dwordx4 v[140:143], v12, s[32:35], s69 offen offset:1024 sc1
	v_pk_mul_f32 v[230:231], v[230:231], v[70:71]
	v_cvt_pk_bf16_f32 v232, v216, v217
	v_cvt_pk_bf16_f32 v233, v218, v219
	v_cvt_pk_bf16_f32 v234, v220, v221
	v_cvt_pk_bf16_f32 v235, v222, v223
	v_cvt_pk_bf16_f32 v236, v224, v225
	v_cvt_pk_bf16_f32 v237, v226, v227
	v_cvt_pk_bf16_f32 v238, v228, v229
	v_cvt_pk_bf16_f32 v239, v230, v231
	s_mul_i32 s63, s13, 0x1c000
	s_add_u32 s63, s63, s4
	buffer_store_dwordx4 v[232:235], v6, s[52:55], s63 offen sc1
	buffer_store_dwordx4 v[236:239], v6, s[52:55], s63 offen offset:1024 sc1
	ds_read_b128 v[208:211], v6 offset:38912
	s_waitcnt lgkmcnt(5)
	v_mfma_f32_32x32x16_bf16 v[24:39], a[0:3], v[184:187], v[240:255]
	ds_read_b128 v[212:215], v6 offset:39936
	v_mfma_f32_32x32x16_bf16 v[24:39], a[4:7], v[188:191], v[24:39]
	buffer_load_dwordx4 v[144:147], v12, s[32:35], s69 offen offset:2048 sc1
	ds_read_b128 v[184:187], v6 offset:40960
	s_waitcnt lgkmcnt(5)
	v_mfma_f32_32x32x16_bf16 v[24:39], a[8:11], v[192:195], v[24:39]
	ds_read_b128 v[188:191], v6 offset:41984
	v_mfma_f32_32x32x16_bf16 v[24:39], a[12:15], v[196:199], v[24:39]
	buffer_load_dwordx4 v[148:151], v12, s[32:35], s69 offen offset:3072 sc1
	ds_read_b128 v[192:195], v6 offset:43008
	s_waitcnt lgkmcnt(5)
	v_mfma_f32_32x32x16_bf16 v[24:39], a[16:19], v[200:203], v[24:39]
	ds_read_b128 v[196:199], v6 offset:44032
	v_mfma_f32_32x32x16_bf16 v[24:39], a[20:23], v[204:207], v[24:39]
	s_add_u32 s69, s9, 0x5000
	buffer_load_dwordx4 v[152:155], v12, s[32:35], s69 offen sc1
	ds_read_b128 v[200:203], v6 offset:45056
	s_waitcnt lgkmcnt(5)
	v_mfma_f32_32x32x16_bf16 v[24:39], a[24:27], v[208:211], v[24:39]
	ds_read_b128 v[204:207], v6 offset:46080
	v_mfma_f32_32x32x16_bf16 v[24:39], a[28:31], v[212:215], v[24:39]
	buffer_load_dwordx4 v[156:159], v12, s[32:35], s69 offen offset:1024 sc1
	ds_read_b128 v[208:211], v6 offset:47104
	s_waitcnt lgkmcnt(5)
	v_mfma_f32_32x32x16_bf16 v[24:39], a[32:35], v[184:187], v[24:39]
	ds_read_b128 v[212:215], v6 offset:48128
	v_mfma_f32_32x32x16_bf16 v[24:39], a[36:39], v[188:191], v[24:39]
	buffer_load_dwordx4 v[160:163], v12, s[32:35], s69 offen offset:2048 sc1
	ds_read_b128 v[184:187], v6 offset:49152
	s_waitcnt lgkmcnt(5)
	v_mfma_f32_32x32x16_bf16 v[24:39], a[40:43], v[192:195], v[24:39]
	ds_read_b128 v[188:191], v6 offset:50176
	v_mfma_f32_32x32x16_bf16 v[24:39], a[44:47], v[196:199], v[24:39]
	buffer_load_dwordx4 v[164:167], v12, s[32:35], s69 offen offset:3072 sc1
	ds_read_b128 v[192:195], v6 offset:51200
	s_waitcnt lgkmcnt(5)
	v_mfma_f32_32x32x16_bf16 v[24:39], a[48:51], v[200:203], v[24:39]
	ds_read_b128 v[196:199], v6 offset:52224
	v_mfma_f32_32x32x16_bf16 v[24:39], a[52:55], v[204:207], v[24:39]
	s_add_u32 s69, s9, 0x6000
	buffer_load_dwordx4 v[168:171], v12, s[32:35], s69 offen sc1
	ds_read_b128 v[200:203], v6 offset:53248
	s_waitcnt lgkmcnt(5)
	v_mfma_f32_32x32x16_bf16 v[24:39], a[56:59], v[208:211], v[24:39]
	ds_read_b128 v[204:207], v6 offset:54272
	v_mfma_f32_32x32x16_bf16 v[24:39], a[60:63], v[212:215], v[24:39]
	buffer_load_dwordx4 v[172:175], v12, s[32:35], s69 offen offset:1024 sc1
	ds_read_b128 v[208:211], v6 offset:55296
	s_waitcnt lgkmcnt(5)
	v_mfma_f32_32x32x16_bf16 v[24:39], a[64:67], v[184:187], v[24:39]
	ds_read_b128 v[212:215], v6 offset:56320
	v_mfma_f32_32x32x16_bf16 v[24:39], a[68:71], v[188:191], v[24:39]
	buffer_load_dwordx4 v[176:179], v12, s[32:35], s69 offen offset:2048 sc1
	ds_read_b128 v[184:187], v6 offset:57344
	s_waitcnt lgkmcnt(5)
	v_mfma_f32_32x32x16_bf16 v[24:39], a[72:75], v[192:195], v[24:39]
	ds_read_b128 v[188:191], v6 offset:58368
	v_mfma_f32_32x32x16_bf16 v[24:39], a[76:79], v[196:199], v[24:39]
	buffer_load_dwordx4 v[180:183], v12, s[32:35], s69 offen offset:3072 sc1
	ds_read_b128 v[192:195], v6 offset:59392
	s_waitcnt lgkmcnt(5)
	v_mfma_f32_32x32x16_bf16 v[24:39], a[80:83], v[200:203], v[24:39]
	ds_read_b128 v[196:199], v6 offset:60416
	v_mfma_f32_32x32x16_bf16 v[24:39], a[84:87], v[204:207], v[24:39]
	ds_read_b128 v[200:203], v6 offset:61440
	s_waitcnt lgkmcnt(5)
	v_mfma_f32_32x32x16_bf16 v[24:39], a[88:91], v[208:211], v[24:39]
	ds_read_b128 v[204:207], v6 offset:62464
	v_mfma_f32_32x32x16_bf16 v[24:39], a[92:95], v[212:215], v[24:39]
	s_waitcnt vmcnt(24)
	s_barrier
	ds_read_b128 v[208:211], v6 offset:63488
	s_waitcnt lgkmcnt(5)
	v_mfma_f32_32x32x16_bf16 v[24:39], a[96:99], v[184:187], v[24:39]
	ds_read_b128 v[212:215], v6 offset:64512
	v_mfma_f32_32x32x16_bf16 v[24:39], a[100:103], v[188:191], v[24:39]
	ds_read_b128 v[184:187], v15
	s_waitcnt lgkmcnt(5)
	v_mfma_f32_32x32x16_bf16 v[24:39], a[104:107], v[192:195], v[24:39]
	s_waitcnt vmcnt(10)
	buffer_atomic_add v9, v7, s[28:31], s68 offen offset:4 sc1
	ds_read_b128 v[188:191], v15 offset:1024
	v_mfma_f32_32x32x16_bf16 v[24:39], a[108:111], v[196:199], v[24:39]
	ds_read_b128 v[192:195], v15 offset:2048
	s_waitcnt lgkmcnt(5)
	v_mfma_f32_32x32x16_bf16 v[24:39], a[112:115], v[200:203], v[24:39]
	ds_read_b128 v[196:199], v15 offset:3072
	v_mfma_f32_32x32x16_bf16 v[24:39], a[116:119], v[204:207], v[24:39]
	ds_read_b128 v[200:203], v15 offset:4096
	s_waitcnt lgkmcnt(5)
	v_mfma_f32_32x32x16_bf16 v[24:39], a[120:123], v[208:211], v[24:39]
	ds_read_b128 v[204:207], v15 offset:5120
	v_mfma_f32_32x32x16_bf16 v[24:39], a[124:127], v[212:215], v[24:39]
	s_nop 11
	v_pk_mul_f32 v[216:217], v[24:25], v[24:25]
	v_pk_mul_f32 v[218:219], v[26:27], v[26:27]
	v_pk_mul_f32 v[220:221], v[28:29], v[28:29]
	v_pk_mul_f32 v[222:223], v[30:31], v[30:31]
	v_pk_mul_f32 v[224:225], v[32:33], v[32:33]
	v_pk_mul_f32 v[226:227], v[34:35], v[34:35]
	v_pk_mul_f32 v[228:229], v[36:37], v[36:37]
	v_pk_mul_f32 v[230:231], v[38:39], v[38:39]
	v_pk_fma_f32 v[216:217], v[216:217], s[10:11], v[20:21]
	v_pk_fma_f32 v[218:219], v[218:219], s[10:11], v[20:21]
	v_pk_fma_f32 v[220:221], v[220:221], s[10:11], v[20:21]
	v_pk_fma_f32 v[222:223], v[222:223], s[10:11], v[20:21]
	v_pk_fma_f32 v[224:225], v[224:225], s[10:11], v[20:21]
	v_pk_fma_f32 v[226:227], v[226:227], s[10:11], v[20:21]
	v_pk_fma_f32 v[228:229], v[228:229], s[10:11], v[20:21]
	v_pk_fma_f32 v[230:231], v[230:231], s[10:11], v[20:21]
	v_pk_mul_f32 v[216:217], v[216:217], v[24:25]
	v_pk_mul_f32 v[218:219], v[218:219], v[26:27]
	v_pk_mul_f32 v[220:221], v[220:221], v[28:29]
	v_pk_mul_f32 v[222:223], v[222:223], v[30:31]
	v_pk_mul_f32 v[224:225], v[224:225], v[32:33]
	v_pk_mul_f32 v[226:227], v[226:227], v[34:35]
	v_pk_mul_f32 v[228:229], v[228:229], v[36:37]
	v_pk_mul_f32 v[230:231], v[230:231], v[38:39]
	v_exp_f32 v216, v216
	v_exp_f32 v217, v217
	v_exp_f32 v218, v218
	v_exp_f32 v219, v219
	v_exp_f32 v220, v220
	v_exp_f32 v221, v221
	v_exp_f32 v222, v222
	v_exp_f32 v223, v223
	v_exp_f32 v224, v224
	v_exp_f32 v225, v225
	v_exp_f32 v226, v226
	v_exp_f32 v227, v227
	v_exp_f32 v228, v228
	v_exp_f32 v229, v229
	v_exp_f32 v230, v230
	v_exp_f32 v231, v231
	s_load_dwordx4 s[64:67], s[6:7], s73 glc
	v_pk_add_f32 v[216:217], v[216:217], 1.0 op_sel_hi:[1,0]
	v_pk_add_f32 v[218:219], v[218:219], 1.0 op_sel_hi:[1,0]
	v_pk_add_f32 v[220:221], v[220:221], 1.0 op_sel_hi:[1,0]
	v_pk_add_f32 v[222:223], v[222:223], 1.0 op_sel_hi:[1,0]
	v_pk_add_f32 v[224:225], v[224:225], 1.0 op_sel_hi:[1,0]
	v_pk_add_f32 v[226:227], v[226:227], 1.0 op_sel_hi:[1,0]
	v_pk_add_f32 v[228:229], v[228:229], 1.0 op_sel_hi:[1,0]
	v_pk_add_f32 v[230:231], v[230:231], 1.0 op_sel_hi:[1,0]
	v_rcp_f32 v216, v216
	v_rcp_f32 v217, v217
	v_rcp_f32 v218, v218
	v_rcp_f32 v219, v219
	v_rcp_f32 v220, v220
	v_rcp_f32 v221, v221
	v_rcp_f32 v222, v222
	v_rcp_f32 v223, v223
	v_rcp_f32 v224, v224
	v_rcp_f32 v225, v225
	v_rcp_f32 v226, v226
	v_rcp_f32 v227, v227
	v_rcp_f32 v228, v228
	v_rcp_f32 v229, v229
	v_rcp_f32 v230, v230
	v_rcp_f32 v231, v231
	v_pk_mul_f32 v[216:217], v[216:217], v[24:25]
	v_pk_mul_f32 v[218:219], v[218:219], v[26:27]
	v_pk_mul_f32 v[220:221], v[220:221], v[28:29]
	v_pk_mul_f32 v[222:223], v[222:223], v[30:31]
	v_pk_mul_f32 v[224:225], v[224:225], v[32:33]
	v_pk_mul_f32 v[226:227], v[226:227], v[34:35]
	v_pk_mul_f32 v[228:229], v[228:229], v[36:37]
	v_pk_mul_f32 v[230:231], v[230:231], v[38:39]
	v_cvt_pk_bf16_f32 v232, v216, v217
	v_cvt_pk_bf16_f32 v233, v218, v219
	v_cvt_pk_bf16_f32 v234, v220, v221
	v_cvt_pk_bf16_f32 v235, v222, v223
	v_cvt_pk_bf16_f32 v236, v224, v225
	v_cvt_pk_bf16_f32 v237, v226, v227
	v_cvt_pk_bf16_f32 v238, v228, v229
	v_cvt_pk_bf16_f32 v239, v230, v231
	s_mul_i32 s63, s14, 0x1c000
	s_add_u32 s63, s63, s4
	buffer_store_dwordx4 v[232:235], v6, s[52:55], s63 offen sc1
	buffer_store_dwordx4 v[236:239], v6, s[52:55], s63 offen offset:1024 sc1
	ds_read_b128 v[208:211], v15 offset:6144
	s_waitcnt lgkmcnt(5)
	v_mfma_f32_32x32x16_bf16 v[56:71], a[0:3], v[184:187], v[240:255]
	ds_read_b128 v[212:215], v15 offset:7168
	v_mfma_f32_32x32x16_bf16 v[56:71], a[4:7], v[188:191], v[56:71]
	s_waitcnt lgkmcnt(0)
	s_cmp_ge_u32 s64, 7
	s_cbranch_scc1 sequential_preLN__spectral_gfnet__mixer_channel_mlp__prompt_kernel_doneb0
	s_mov_b32 s62, 0x80000
sequential_preLN__spectral_gfnet__mixer_channel_mlp__prompt_kernel_pollb0:
	s_load_dwordx4 s[64:67], s[6:7], s73 glc
	s_waitcnt lgkmcnt(0)
	s_cmp_ge_u32 s64, 7
	s_cbranch_scc1 sequential_preLN__spectral_gfnet__mixer_channel_mlp__prompt_kernel_doneb0
	s_sub_u32 s62, s62, 1
	s_cmp_lg_u32 s62, 0
	s_cbranch_scc1 sequential_preLN__spectral_gfnet__mixer_channel_mlp__prompt_kernel_pollb0
sequential_preLN__spectral_gfnet__mixer_channel_mlp__prompt_kernel_doneb0:
	ds_read_b128 v[184:187], v15 offset:8192
	v_mfma_f32_32x32x16_bf16 v[56:71], a[8:11], v[192:195], v[56:71]
	ds_read_b128 v[188:191], v15 offset:9216
	v_mfma_f32_32x32x16_bf16 v[56:71], a[12:15], v[196:199], v[56:71]
	s_add_u32 s16, s74, 0
	buffer_load_dwordx4 a[0:3], v6, s[52:55], s16 offen sc1
	ds_read_b128 v[192:195], v15 offset:10240
	v_mfma_f32_32x32x16_bf16 v[56:71], a[16:19], v[200:203], v[56:71]
	ds_read_b128 v[196:199], v15 offset:11264
	v_mfma_f32_32x32x16_bf16 v[56:71], a[20:23], v[204:207], v[56:71]
	buffer_load_dwordx4 a[4:7], v6, s[52:55], s16 offen offset:1024 sc1
	ds_read_b128 v[200:203], v15 offset:12288
	v_mfma_f32_32x32x16_bf16 v[56:71], a[24:27], v[208:211], v[56:71]
	ds_read_b128 v[204:207], v15 offset:13312
	v_mfma_f32_32x32x16_bf16 v[56:71], a[28:31], v[212:215], v[56:71]
	buffer_load_dwordx4 a[8:11], v6, s[52:55], s16 offen offset:2048 sc1
	ds_read_b128 v[208:211], v15 offset:14336
	s_waitcnt lgkmcnt(5)
	v_mfma_f32_32x32x16_bf16 v[56:71], a[32:35], v[184:187], v[56:71]
	ds_read_b128 v[212:215], v15 offset:15360
	v_mfma_f32_32x32x16_bf16 v[56:71], a[36:39], v[188:191], v[56:71]
	buffer_load_dwordx4 a[12:15], v6, s[52:55], s16 offen offset:3072 sc1
	ds_read_b128 v[184:187], v15 offset:16384
	s_waitcnt lgkmcnt(5)
	v_mfma_f32_32x32x16_bf16 v[56:71], a[40:43], v[192:195], v[56:71]
	ds_read_b128 v[188:191], v15 offset:17408
	v_mfma_f32_32x32x16_bf16 v[56:71], a[44:47], v[196:199], v[56:71]
	s_add_u32 s16, s74, 0x1000
	buffer_load_dwordx4 a[16:19], v6, s[52:55], s16 offen sc1
	ds_read_b128 v[192:195], v15 offset:18432
	s_waitcnt lgkmcnt(5)
	v_mfma_f32_32x32x16_bf16 v[56:71], a[48:51], v[200:203], v[56:71]
	ds_read_b128 v[196:199], v15 offset:19456
	v_mfma_f32_32x32x16_bf16 v[56:71], a[52:55], v[204:207], v[56:71]
	buffer_load_dwordx4 a[20:23], v6, s[52:55], s16 offen offset:1024 sc1
	ds_read_b128 v[200:203], v15 offset:20480
	s_waitcnt lgkmcnt(5)
	v_mfma_f32_32x32x16_bf16 v[56:71], a[56:59], v[208:211], v[56:71]
	ds_read_b128 v[204:207], v15 offset:21504
	v_mfma_f32_32x32x16_bf16 v[56:71], a[60:63], v[212:215], v[56:71]
	buffer_load_dwordx4 a[24:27], v6, s[52:55], s16 offen offset:2048 sc1
	ds_read_b128 v[208:211], v15 offset:22528
	s_waitcnt lgkmcnt(5)
	v_mfma_f32_32x32x16_bf16 v[56:71], a[64:67], v[184:187], v[56:71]
	ds_read_b128 v[212:215], v15 offset:23552
	v_mfma_f32_32x32x16_bf16 v[56:71], a[68:71], v[188:191], v[56:71]
	buffer_load_dwordx4 a[28:31], v6, s[52:55], s16 offen offset:3072 sc1
	ds_read_b128 v[184:187], v15 offset:24576
	s_waitcnt lgkmcnt(5)
	v_mfma_f32_32x32x16_bf16 v[56:71], a[72:75], v[192:195], v[56:71]
	ds_read_b128 v[188:191], v15 offset:25600
	v_mfma_f32_32x32x16_bf16 v[56:71], a[76:79], v[196:199], v[56:71]
	s_add_u32 s16, s74, 0x2000
	buffer_load_dwordx4 a[32:35], v6, s[52:55], s16 offen sc1
	ds_read_b128 v[192:195], v15 offset:26624
	s_waitcnt lgkmcnt(5)
	v_mfma_f32_32x32x16_bf16 v[56:71], a[80:83], v[200:203], v[56:71]
	ds_read_b128 v[196:199], v15 offset:27648
	v_mfma_f32_32x32x16_bf16 v[56:71], a[84:87], v[204:207], v[56:71]
	buffer_load_dwordx4 a[36:39], v6, s[52:55], s16 offen offset:1024 sc1
	ds_read_b128 v[200:203], v15 offset:28672
	s_waitcnt lgkmcnt(5)
	v_mfma_f32_32x32x16_bf16 v[56:71], a[88:91], v[208:211], v[56:71]
	ds_read_b128 v[204:207], v15 offset:29696
	v_mfma_f32_32x32x16_bf16 v[56:71], a[92:95], v[212:215], v[56:71]
	buffer_load_dwordx4 a[40:43], v6, s[52:55], s16 offen offset:2048 sc1
	ds_read_b128 v[208:211], v15 offset:30720
	s_waitcnt lgkmcnt(5)
	v_mfma_f32_32x32x16_bf16 v[56:71], a[96:99], v[184:187], v[56:71]
	ds_read_b128 v[212:215], v15 offset:31744
	v_mfma_f32_32x32x16_bf16 v[56:71], a[100:103], v[188:191], v[56:71]
	buffer_load_dwordx4 a[44:47], v6, s[52:55], s16 offen offset:3072 sc1
	s_waitcnt lgkmcnt(4)
	v_mfma_f32_32x32x16_bf16 v[56:71], a[104:107], v[192:195], v[56:71]
	s_waitcnt vmcnt(12)
	buffer_atomic_add v9, v7, s[28:31], s5 offen offset:8 sc1
	v_mfma_f32_32x32x16_bf16 v[56:71], a[108:111], v[196:199], v[56:71]
	s_add_u32 s16, s74, 0x3000
	buffer_load_dwordx4 a[48:51], v6, s[52:55], s16 offen sc1
	s_waitcnt lgkmcnt(2)
	v_mfma_f32_32x32x16_bf16 v[56:71], a[112:115], v[200:203], v[56:71]
	v_mfma_f32_32x32x16_bf16 v[56:71], a[116:119], v[204:207], v[56:71]
	buffer_load_dwordx4 a[52:55], v6, s[52:55], s16 offen offset:1024 sc1
	s_waitcnt lgkmcnt(0)
	v_mfma_f32_32x32x16_bf16 v[56:71], a[120:123], v[208:211], v[56:71]
	v_mfma_f32_32x32x16_bf16 v[56:71], a[124:127], v[212:215], v[56:71]
	s_load_dwordx4 s[64:67], s[6:7], s73 glc
	s_nop 10
	v_pk_mul_f32 v[216:217], v[56:57], v[56:57]
	v_pk_mul_f32 v[218:219], v[58:59], v[58:59]
	v_pk_mul_f32 v[220:221], v[60:61], v[60:61]
	v_pk_mul_f32 v[222:223], v[62:63], v[62:63]
	v_pk_mul_f32 v[224:225], v[64:65], v[64:65]
	v_pk_mul_f32 v[226:227], v[66:67], v[66:67]
	v_pk_mul_f32 v[228:229], v[68:69], v[68:69]
	v_pk_mul_f32 v[230:231], v[70:71], v[70:71]
	v_pk_fma_f32 v[216:217], v[216:217], s[10:11], v[20:21]
	v_pk_fma_f32 v[218:219], v[218:219], s[10:11], v[20:21]
	v_pk_fma_f32 v[220:221], v[220:221], s[10:11], v[20:21]
	v_pk_fma_f32 v[222:223], v[222:223], s[10:11], v[20:21]
	v_pk_fma_f32 v[224:225], v[224:225], s[10:11], v[20:21]
	v_pk_fma_f32 v[226:227], v[226:227], s[10:11], v[20:21]
	v_pk_fma_f32 v[228:229], v[228:229], s[10:11], v[20:21]
	v_pk_fma_f32 v[230:231], v[230:231], s[10:11], v[20:21]
	s_waitcnt lgkmcnt(0)
	s_cmp_ge_u32 s65, 7
	s_cbranch_scc1 sequential_preLN__spectral_gfnet__mixer_channel_mlp__prompt_kernel_doneb1
	s_mov_b32 s62, 0x80000
sequential_preLN__spectral_gfnet__mixer_channel_mlp__prompt_kernel_pollb1:
	s_load_dwordx4 s[64:67], s[6:7], s73 glc
	s_waitcnt lgkmcnt(0)
	s_cmp_ge_u32 s65, 7
	s_cbranch_scc1 sequential_preLN__spectral_gfnet__mixer_channel_mlp__prompt_kernel_doneb1
	s_sub_u32 s62, s62, 1
	s_cmp_lg_u32 s62, 0
	s_cbranch_scc1 sequential_preLN__spectral_gfnet__mixer_channel_mlp__prompt_kernel_pollb1
sequential_preLN__spectral_gfnet__mixer_channel_mlp__prompt_kernel_doneb1:
	v_pk_mul_f32 v[216:217], v[216:217], v[56:57]
	v_pk_mul_f32 v[218:219], v[218:219], v[58:59]
	v_pk_mul_f32 v[220:221], v[220:221], v[60:61]
	v_pk_mul_f32 v[222:223], v[222:223], v[62:63]
	v_pk_mul_f32 v[224:225], v[224:225], v[64:65]
	v_pk_mul_f32 v[226:227], v[226:227], v[66:67]
	v_pk_mul_f32 v[228:229], v[228:229], v[68:69]
	v_pk_mul_f32 v[230:231], v[230:231], v[70:71]
	s_add_u32 s16, s75, 0
	buffer_load_dwordx4 a[56:59], v6, s[52:55], s16 offen sc1
	v_exp_f32 v216, v216
	v_exp_f32 v217, v217
	v_exp_f32 v218, v218
	v_exp_f32 v219, v219
	v_exp_f32 v220, v220
	v_exp_f32 v221, v221
	v_exp_f32 v222, v222
	v_exp_f32 v223, v223
	buffer_load_dwordx4 a[60:63], v6, s[52:55], s16 offen offset:1024 sc1
	v_exp_f32 v224, v224
	v_exp_f32 v225, v225
	v_exp_f32 v226, v226
	v_exp_f32 v227, v227
	v_exp_f32 v228, v228
	v_exp_f32 v229, v229
	v_exp_f32 v230, v230
	v_exp_f32 v231, v231
	buffer_load_dwordx4 a[64:67], v6, s[52:55], s16 offen offset:2048 sc1
	v_pk_add_f32 v[216:217], v[216:217], 1.0 op_sel_hi:[1,0]
	v_pk_add_f32 v[218:219], v[218:219], 1.0 op_sel_hi:[1,0]
	v_pk_add_f32 v[220:221], v[220:221], 1.0 op_sel_hi:[1,0]
	v_pk_add_f32 v[222:223], v[222:223], 1.0 op_sel_hi:[1,0]
	v_pk_add_f32 v[224:225], v[224:225], 1.0 op_sel_hi:[1,0]
	v_pk_add_f32 v[226:227], v[226:227], 1.0 op_sel_hi:[1,0]
	v_pk_add_f32 v[228:229], v[228:229], 1.0 op_sel_hi:[1,0]
	v_pk_add_f32 v[230:231], v[230:231], 1.0 op_sel_hi:[1,0]
	buffer_load_dwordx4 a[68:71], v6, s[52:55], s16 offen offset:3072 sc1
	v_rcp_f32 v216, v216
	v_rcp_f32 v217, v217
	v_rcp_f32 v218, v218
	v_rcp_f32 v219, v219
	v_rcp_f32 v220, v220
	v_rcp_f32 v221, v221
	v_rcp_f32 v222, v222
	v_rcp_f32 v223, v223
	s_add_u32 s16, s75, 0x1000
	buffer_load_dwordx4 a[72:75], v6, s[52:55], s16 offen sc1
	v_rcp_f32 v224, v224
	v_rcp_f32 v225, v225
	v_rcp_f32 v226, v226
	v_rcp_f32 v227, v227
	v_rcp_f32 v228, v228
	v_rcp_f32 v229, v229
	v_rcp_f32 v230, v230
	v_rcp_f32 v231, v231
	buffer_load_dwordx4 a[76:79], v6, s[52:55], s16 offen offset:1024 sc1
	v_pk_mul_f32 v[216:217], v[216:217], v[56:57]
	v_pk_mul_f32 v[218:219], v[218:219], v[58:59]
	v_pk_mul_f32 v[220:221], v[220:221], v[60:61]
	v_pk_mul_f32 v[222:223], v[222:223], v[62:63]
	v_pk_mul_f32 v[224:225], v[224:225], v[64:65]
	v_pk_mul_f32 v[226:227], v[226:227], v[66:67]
	v_pk_mul_f32 v[228:229], v[228:229], v[68:69]
	v_pk_mul_f32 v[230:231], v[230:231], v[70:71]
	buffer_load_dwordx4 a[80:83], v6, s[52:55], s16 offen offset:2048 sc1
	v_cvt_pk_bf16_f32 v232, v216, v217
	v_cvt_pk_bf16_f32 v233, v218, v219
	v_cvt_pk_bf16_f32 v234, v220, v221
	v_cvt_pk_bf16_f32 v235, v222, v223
	v_cvt_pk_bf16_f32 v236, v224, v225
	v_cvt_pk_bf16_f32 v237, v226, v227
	v_cvt_pk_bf16_f32 v238, v228, v229
	v_cvt_pk_bf16_f32 v239, v230, v231
	buffer_load_dwordx4 a[84:87], v6, s[52:55], s16 offen offset:3072 sc1
	s_mul_i32 s63, s15, 0x1c000
	s_add_u32 s63, s63, s4
	buffer_store_dwordx4 v[232:235], v6, s[52:55], s63 offen sc1
	buffer_store_dwordx4 v[236:239], v6, s[52:55], s63 offen offset:1024 sc1
	s_waitcnt vmcnt(24)
	v_mfma_f32_32x32x16_bf16 v[24:39], a[128:131], a[0:3], 0
	s_add_u32 s16, s75, 0x2000
	buffer_load_dwordx4 a[88:91], v6, s[52:55], s16 offen sc1
	v_mfma_f32_32x32x16_bf16 v[40:55], a[132:135], a[0:3], 0
	s_waitcnt vmcnt(24)
	v_mfma_f32_32x32x16_bf16 v[24:39], a[136:139], a[4:7], v[24:39]
	buffer_load_dwordx4 a[92:95], v6, s[52:55], s16 offen offset:1024 sc1
	v_mfma_f32_32x32x16_bf16 v[40:55], a[140:143], a[4:7], v[40:55]
	s_waitcnt vmcnt(24)
	v_mfma_f32_32x32x16_bf16 v[24:39], a[144:147], a[8:11], v[24:39]
	buffer_load_dwordx4 a[96:99], v6, s[52:55], s16 offen offset:2048 sc1
	v_mfma_f32_32x32x16_bf16 v[40:55], a[148:151], a[8:11], v[40:55]
	s_waitcnt vmcnt(24)
	v_mfma_f32_32x32x16_bf16 v[24:39], a[152:155], a[12:15], v[24:39]
	buffer_load_dwordx4 a[100:103], v6, s[52:55], s16 offen offset:3072 sc1
	v_mfma_f32_32x32x16_bf16 v[40:55], a[156:159], a[12:15], v[40:55]
	s_waitcnt vmcnt(24)
	v_mfma_f32_32x32x16_bf16 v[24:39], a[160:163], a[16:19], v[24:39]
	s_add_u32 s16, s75, 0x3000
	buffer_load_dwordx4 a[104:107], v6, s[52:55], s16 offen sc1
	v_mfma_f32_32x32x16_bf16 v[40:55], a[164:167], a[16:19], v[40:55]
	s_waitcnt vmcnt(24)
	v_mfma_f32_32x32x16_bf16 v[24:39], a[168:171], a[20:23], v[24:39]
	buffer_load_dwordx4 a[108:111], v6, s[52:55], s16 offen offset:1024 sc1
	v_mfma_f32_32x32x16_bf16 v[40:55], a[172:175], a[20:23], v[40:55]
	s_waitcnt vmcnt(24)
	v_mfma_f32_32x32x16_bf16 v[24:39], a[176:179], a[24:27], v[24:39]
	v_mfma_f32_32x32x16_bf16 v[40:55], a[180:183], a[24:27], v[40:55]
	s_waitcnt vmcnt(23)
	v_mfma_f32_32x32x16_bf16 v[24:39], a[184:187], a[28:31], v[24:39]
	s_waitcnt vmcnt(6)
	buffer_atomic_add v9, v7, s[28:31], s68 offen offset:12 sc1
	v_mfma_f32_32x32x16_bf16 v[40:55], a[188:191], a[28:31], v[40:55]
	v_mfma_f32_32x32x16_bf16 v[24:39], a[192:195], a[32:35], v[24:39]
	v_mfma_f32_32x32x16_bf16 v[40:55], a[196:199], a[32:35], v[40:55]
	v_mfma_f32_32x32x16_bf16 v[24:39], a[200:203], a[36:39], v[24:39]
	v_mfma_f32_32x32x16_bf16 v[40:55], a[204:207], a[36:39], v[40:55]
	v_mfma_f32_32x32x16_bf16 v[24:39], a[208:211], a[40:43], v[24:39]
	s_load_dwordx4 s[64:67], s[6:7], s73 glc
	v_mfma_f32_32x32x16_bf16 v[40:55], a[212:215], a[40:43], v[40:55]
	v_mfma_f32_32x32x16_bf16 v[24:39], a[216:219], a[44:47], v[24:39]
	buffer_load_dwordx4 v[216:219], v4, s[36:39], s80 offen sc1
	v_mfma_f32_32x32x16_bf16 v[40:55], a[220:223], a[44:47], v[40:55]
	v_mfma_f32_32x32x16_bf16 v[24:39], a[224:227], a[48:51], v[24:39]
	buffer_load_dwordx4 v[220:223], v4, s[36:39], s81 offen sc1
	v_mfma_f32_32x32x16_bf16 v[40:55], a[228:231], a[48:51], v[40:55]
	v_mfma_f32_32x32x16_bf16 v[24:39], a[232:235], a[52:55], v[24:39]
	buffer_load_dwordx4 v[224:227], v10, s[48:51], s76 offen
	v_mfma_f32_32x32x16_bf16 v[40:55], a[236:239], a[52:55], v[40:55]
sequential_preLN__spectral_gfnet__mixer_channel_mlp__prompt_kernel_g2:
	s_nop 0
	s_waitcnt lgkmcnt(0)
	s_cmp_ge_u32 s66, 7
	s_cbranch_scc1 sequential_preLN__spectral_gfnet__mixer_channel_mlp__prompt_kernel_doneb2
	s_mov_b32 s62, 0x80000
sequential_preLN__spectral_gfnet__mixer_channel_mlp__prompt_kernel_pollb2:
	s_load_dwordx4 s[64:67], s[6:7], s73 glc
	s_waitcnt lgkmcnt(0)
	s_cmp_ge_u32 s66, 7
	s_cbranch_scc1 sequential_preLN__spectral_gfnet__mixer_channel_mlp__prompt_kernel_doneb2
	s_sub_u32 s62, s62, 1
	s_cmp_lg_u32 s62, 0
	s_cbranch_scc1 sequential_preLN__spectral_gfnet__mixer_channel_mlp__prompt_kernel_pollb2
sequential_preLN__spectral_gfnet__mixer_channel_mlp__prompt_kernel_doneb2:
	v_mfma_f32_32x32x16_bf16 v[24:39], a[240:243], a[56:59], v[24:39]
	s_add_u32 s16, s74, 0x1c000
	buffer_load_dwordx4 a[0:3], v6, s[52:55], s16 offen sc1
	v_mfma_f32_32x32x16_bf16 v[40:55], a[244:247], a[56:59], v[40:55]
	buffer_load_dwordx4 a[4:7], v6, s[52:55], s16 offen offset:1024 sc1
	v_mfma_f32_32x32x16_bf16 v[24:39], a[248:251], a[60:63], v[24:39]
	buffer_load_dwordx4 a[8:11], v6, s[52:55], s16 offen offset:2048 sc1
	v_mfma_f32_32x32x16_bf16 v[40:55], a[252:255], a[60:63], v[40:55]
	buffer_load_dwordx4 a[12:15], v6, s[52:55], s16 offen offset:3072 sc1
	v_mfma_f32_32x32x16_bf16 v[24:39], v[88:91], a[64:67], v[24:39]
	s_add_u32 s16, s74, 0x1d000
	buffer_load_dwordx4 a[16:19], v6, s[52:55], s16 offen sc1
	v_mfma_f32_32x32x16_bf16 v[40:55], v[92:95], a[64:67], v[40:55]
	buffer_load_dwordx4 a[20:23], v6, s[52:55], s16 offen offset:1024 sc1
	v_mfma_f32_32x32x16_bf16 v[24:39], v[96:99], a[68:71], v[24:39]
	buffer_load_dwordx4 a[24:27], v6, s[52:55], s16 offen offset:2048 sc1
	v_mfma_f32_32x32x16_bf16 v[40:55], v[100:103], a[68:71], v[40:55]
	buffer_load_dwordx4 a[28:31], v6, s[52:55], s16 offen offset:3072 sc1
	v_mfma_f32_32x32x16_bf16 v[24:39], v[104:107], a[72:75], v[24:39]
	s_add_u32 s16, s74, 0x1e000
	buffer_load_dwordx4 a[32:35], v6, s[52:55], s16 offen sc1
	v_mfma_f32_32x32x16_bf16 v[40:55], v[108:111], a[72:75], v[40:55]
	buffer_load_dwordx4 a[36:39], v6, s[52:55], s16 offen offset:1024 sc1
	v_mfma_f32_32x32x16_bf16 v[24:39], v[112:115], a[76:79], v[24:39]
	buffer_load_dwordx4 a[40:43], v6, s[52:55], s16 offen offset:2048 sc1
	v_mfma_f32_32x32x16_bf16 v[40:55], v[116:119], a[76:79], v[40:55]
	buffer_load_dwordx4 a[44:47], v6, s[52:55], s16 offen offset:3072 sc1
	v_mfma_f32_32x32x16_bf16 v[24:39], v[120:123], a[80:83], v[24:39]
	s_add_u32 s16, s74, 0x1f000
	buffer_load_dwordx4 a[48:51], v6, s[52:55], s16 offen sc1
	v_mfma_f32_32x32x16_bf16 v[40:55], v[124:127], a[80:83], v[40:55]
	buffer_load_dwordx4 a[52:55], v6, s[52:55], s16 offen offset:1024 sc1
	v_mfma_f32_32x32x16_bf16 v[24:39], v[128:131], a[84:87], v[24:39]
	v_mfma_f32_32x32x16_bf16 v[40:55], v[132:135], a[84:87], v[40:55]
	s_waitcnt vmcnt(23)
	v_mfma_f32_32x32x16_bf16 v[24:39], v[136:139], a[88:91], v[24:39]
	v_mfma_f32_32x32x16_bf16 v[40:55], v[140:143], a[88:91], v[40:55]
	s_waitcnt vmcnt(22)
	v_mfma_f32_32x32x16_bf16 v[24:39], v[144:147], a[92:95], v[24:39]
	v_mfma_f32_32x32x16_bf16 v[40:55], v[148:151], a[92:95], v[40:55]
	s_waitcnt vmcnt(21)
	v_mfma_f32_32x32x16_bf16 v[24:39], v[152:155], a[96:99], v[24:39]
	s_load_dwordx4 s[64:67], s[6:7], s73 glc
	v_mfma_f32_32x32x16_bf16 v[40:55], v[156:159], a[96:99], v[40:55]
	s_waitcnt vmcnt(20)
	v_mfma_f32_32x32x16_bf16 v[24:39], v[160:163], a[100:103], v[24:39]
	v_mfma_f32_32x32x16_bf16 v[40:55], v[164:167], a[100:103], v[40:55]
	s_waitcnt vmcnt(19)
	v_mfma_f32_32x32x16_bf16 v[24:39], v[168:171], a[104:107], v[24:39]
	v_mfma_f32_32x32x16_bf16 v[40:55], v[172:175], a[104:107], v[40:55]
	s_waitcnt vmcnt(18)
	v_mfma_f32_32x32x16_bf16 v[24:39], v[176:179], a[108:111], v[24:39]
	v_mfma_f32_32x32x16_bf16 v[40:55], v[180:183], a[108:111], v[40:55]
	s_waitcnt vmcnt(13)
	v_mfma_f32_32x32x16_bf16 v[56:71], a[128:131], a[0:3], 0
	s_waitcnt lgkmcnt(0)
	s_cmp_ge_u32 s67, 7
	s_cbranch_scc1 sequential_preLN__spectral_gfnet__mixer_channel_mlp__prompt_kernel_doneb3
	s_mov_b32 s62, 0x80000
sequential_preLN__spectral_gfnet__mixer_channel_mlp__prompt_kernel_pollb3:
	s_load_dwordx4 s[64:67], s[6:7], s73 glc
	s_waitcnt lgkmcnt(0)
	s_cmp_ge_u32 s67, 7
	s_cbranch_scc1 sequential_preLN__spectral_gfnet__mixer_channel_mlp__prompt_kernel_doneb3
	s_sub_u32 s62, s62, 1
	s_cmp_lg_u32 s62, 0
	s_cbranch_scc1 sequential_preLN__spectral_gfnet__mixer_channel_mlp__prompt_kernel_pollb3
sequential_preLN__spectral_gfnet__mixer_channel_mlp__prompt_kernel_doneb3:
	v_lshlrev_b32 v240, 16, v216
	v_lshlrev_b32 v2, 16, v224
	v_add_f32 v240, v240, v2
	v_mfma_f32_32x32x16_bf16 v[72:87], a[132:135], a[0:3], 0
	v_and_b32 v244, 0xffff0000, v216
	v_and_b32 v2, 0xffff0000, v224
	v_add_f32 v244, v244, v2
	s_waitcnt vmcnt(12)
	v_mfma_f32_32x32x16_bf16 v[56:71], a[136:139], a[4:7], v[56:71]
	s_add_u32 s16, s75, 0x1c000
	buffer_load_dwordx4 a[112:115], v6, s[52:55], s16 offen sc1
	buffer_load_dwordx4 a[116:119], v6, s[52:55], s16 offen offset:1024 sc1
	buffer_load_dwordx4 a[120:123], v6, s[52:55], s16 offen offset:2048 sc1
	v_mfma_f32_32x32x16_bf16 v[72:87], a[140:143], a[4:7], v[72:87]
	v_lshlrev_b32 v241, 16, v217
	v_lshlrev_b32 v2, 16, v225
	v_add_f32 v241, v241, v2
	v_and_b32 v245, 0xffff0000, v217
	v_and_b32 v2, 0xffff0000, v225
	v_add_f32 v245, v245, v2
	s_waitcnt vmcnt(14)
	v_mfma_f32_32x32x16_bf16 v[56:71], a[144:147], a[8:11], v[56:71]
	buffer_load_dwordx4 a[124:127], v6, s[52:55], s16 offen offset:3072 sc1
	s_add_u32 s16, s75, 0x1d000
	buffer_load_dwordx4 v[184:187], v6, s[52:55], s16 offen sc1
	buffer_load_dwordx4 v[188:191], v6, s[52:55], s16 offen offset:1024 sc1
	v_mfma_f32_32x32x16_bf16 v[72:87], a[148:151], a[8:11], v[72:87]
	v_lshlrev_b32 v242, 16, v218
	v_lshlrev_b32 v2, 16, v226
	v_add_f32 v242, v242, v2
	v_and_b32 v246, 0xffff0000, v218
	v_and_b32 v2, 0xffff0000, v226
	v_add_f32 v246, v246, v2
	s_waitcnt vmcnt(16)
	v_mfma_f32_32x32x16_bf16 v[56:71], a[152:155], a[12:15], v[56:71]
	buffer_load_dwordx4 v[192:195], v6, s[52:55], s16 offen offset:2048 sc1
	buffer_load_dwordx4 v[196:199], v6, s[52:55], s16 offen offset:3072 sc1
	s_add_u32 s16, s75, 0x1e000
	buffer_load_dwordx4 v[200:203], v6, s[52:55], s16 offen sc1
	v_mfma_f32_32x32x16_bf16 v[72:87], a[156:159], a[12:15], v[72:87]
	v_lshlrev_b32 v243, 16, v219
	v_lshlrev_b32 v2, 16, v227
	v_add_f32 v243, v243, v2
	v_and_b32 v247, 0xffff0000, v219
	v_and_b32 v2, 0xffff0000, v227
	v_add_f32 v247, v247, v2
	s_waitcnt vmcnt(18)
	v_mfma_f32_32x32x16_bf16 v[56:71], a[160:163], a[16:19], v[56:71]
	buffer_load_dwordx4 v[204:207], v6, s[52:55], s16 offen offset:1024 sc1
	buffer_load_dwordx4 v[208:211], v6, s[52:55], s16 offen offset:2048 sc1
	buffer_load_dwordx4 v[212:215], v6, s[52:55], s16 offen offset:3072 sc1
	v_mfma_f32_32x32x16_bf16 v[72:87], a[164:167], a[16:19], v[72:87]
	v_lshlrev_b32 v248, 16, v220
	v_lshlrev_b32 v2, 16, v224
	v_add_f32 v248, v248, v2
	v_and_b32 v252, 0xffff0000, v220
	v_and_b32 v2, 0xffff0000, v224
	v_add_f32 v252, v252, v2
	s_waitcnt vmcnt(20)
	v_mfma_f32_32x32x16_bf16 v[56:71], a[168:171], a[20:23], v[56:71]
	s_add_u32 s16, s75, 0x1f000
	buffer_load_dwordx4 v[232:235], v6, s[52:55], s16 offen sc1
	buffer_load_dwordx4 v[236:239], v6, s[52:55], s16 offen offset:1024 sc1
	v_mfma_f32_32x32x16_bf16 v[72:87], a[172:175], a[20:23], v[72:87]
	v_lshlrev_b32 v249, 16, v221
	v_lshlrev_b32 v2, 16, v225
	v_add_f32 v249, v249, v2
	v_and_b32 v253, 0xffff0000, v221
	v_and_b32 v2, 0xffff0000, v225
	v_add_f32 v253, v253, v2
	s_waitcnt vmcnt(21)
	v_mfma_f32_32x32x16_bf16 v[56:71], a[176:179], a[24:27], v[56:71]
	ds_write_b128 v16, v[28:31]
	v_lshlrev_b32 v250, 16, v222
	v_lshlrev_b32 v2, 16, v226
	v_add_f32 v250, v250, v2
	v_mfma_f32_32x32x16_bf16 v[72:87], a[180:183], a[24:27], v[72:87]
	v_and_b32 v254, 0xffff0000, v222
	v_and_b32 v2, 0xffff0000, v226
	v_add_f32 v254, v254, v2
	s_waitcnt vmcnt(20)
	v_mfma_f32_32x32x16_bf16 v[56:71], a[184:187], a[28:31], v[56:71]
	ds_write_b128 v16, v[44:47] offset:1024
	v_lshlrev_b32 v251, 16, v223
	v_lshlrev_b32 v2, 16, v227
	v_add_f32 v251, v251, v2
	v_mfma_f32_32x32x16_bf16 v[72:87], a[188:191], a[28:31], v[72:87]
	v_and_b32 v255, 0xffff0000, v223
	v_and_b32 v2, 0xffff0000, v227
	v_add_f32 v255, v255, v2
	s_waitcnt vmcnt(19)
	v_mfma_f32_32x32x16_bf16 v[56:71], a[192:195], a[32:35], v[56:71]
	ds_write_b128 v17, v[32:35]
	v_mfma_f32_32x32x16_bf16 v[72:87], a[196:199], a[32:35], v[72:87]
	s_waitcnt vmcnt(18)
	v_mfma_f32_32x32x16_bf16 v[56:71], a[200:203], a[36:39], v[56:71]
	ds_write_b128 v17, v[48:51] offset:1024
	v_mfma_f32_32x32x16_bf16 v[72:87], a[204:207], a[36:39], v[72:87]
	s_waitcnt vmcnt(17)
	v_mfma_f32_32x32x16_bf16 v[56:71], a[208:211], a[40:43], v[56:71]
	ds_write_b128 v18, v[36:39]
	v_mfma_f32_32x32x16_bf16 v[72:87], a[212:215], a[40:43], v[72:87]
	s_waitcnt vmcnt(16)
	v_mfma_f32_32x32x16_bf16 v[56:71], a[216:219], a[44:47], v[56:71]
	ds_write_b128 v18, v[52:55] offset:1024
	v_mfma_f32_32x32x16_bf16 v[72:87], a[220:223], a[44:47], v[72:87]
	s_waitcnt vmcnt(15)
	v_mfma_f32_32x32x16_bf16 v[56:71], a[224:227], a[48:51], v[56:71]
	v_mfma_f32_32x32x16_bf16 v[72:87], a[228:231], a[48:51], v[72:87]
	s_waitcnt vmcnt(14)
	v_mfma_f32_32x32x16_bf16 v[56:71], a[232:235], a[52:55], v[56:71]
	v_mfma_f32_32x32x16_bf16 v[72:87], a[236:239], a[52:55], v[72:87]
	s_waitcnt lgkmcnt(0)
	s_barrier
	s_waitcnt vmcnt(13)
	v_mfma_f32_32x32x16_bf16 v[56:71], a[240:243], a[112:115], v[56:71]
	ds_read_b128 v[28:31], v11
	v_mfma_f32_32x32x16_bf16 v[72:87], a[244:247], a[112:115], v[72:87]
	ds_read_b128 v[44:47], v11 offset:1024
	s_waitcnt vmcnt(12)
	v_mfma_f32_32x32x16_bf16 v[56:71], a[248:251], a[116:119], v[56:71]
	ds_read_b128 v[32:35], v11 offset:2048
	v_mfma_f32_32x32x16_bf16 v[72:87], a[252:255], a[116:119], v[72:87]
	ds_read_b128 v[48:51], v11 offset:3072
	s_waitcnt vmcnt(11)
	v_mfma_f32_32x32x16_bf16 v[56:71], v[88:91], a[120:123], v[56:71]
	ds_read_b128 v[36:39], v11 offset:4096
	v_mfma_f32_32x32x16_bf16 v[72:87], v[92:95], a[120:123], v[72:87]
	ds_read_b128 v[52:55], v11 offset:5120
	s_waitcnt vmcnt(10)
	v_mfma_f32_32x32x16_bf16 v[56:71], v[96:99], a[124:127], v[56:71]
	v_add_f32 v24, v24, v240
	v_add_f32 v25, v25, v241
	v_mfma_f32_32x32x16_bf16 v[72:87], v[100:103], a[124:127], v[72:87]
	v_add_f32 v26, v26, v242
	v_add_f32 v27, v27, v243
	s_waitcnt vmcnt(9)
	v_mfma_f32_32x32x16_bf16 v[56:71], v[104:107], v[184:187], v[56:71]
	s_waitcnt lgkmcnt(5)
	v_add_f32 v24, v24, v28
	v_add_f32 v25, v25, v29
	v_mfma_f32_32x32x16_bf16 v[72:87], v[108:111], v[184:187], v[72:87]
	v_add_f32 v26, v26, v30
	v_add_f32 v27, v27, v31
	s_waitcnt vmcnt(8)
	v_mfma_f32_32x32x16_bf16 v[56:71], v[112:115], v[188:191], v[56:71]
	s_waitcnt lgkmcnt(3)
	v_add_f32 v24, v24, v32
	v_add_f32 v25, v25, v33
	v_mfma_f32_32x32x16_bf16 v[72:87], v[116:119], v[188:191], v[72:87]
	v_add_f32 v26, v26, v34
	v_add_f32 v27, v27, v35
	s_waitcnt vmcnt(7)
	v_mfma_f32_32x32x16_bf16 v[56:71], v[120:123], v[192:195], v[56:71]
	s_waitcnt lgkmcnt(1)
	v_add_f32 v24, v24, v36
	v_add_f32 v25, v25, v37
	v_mfma_f32_32x32x16_bf16 v[72:87], v[124:127], v[192:195], v[72:87]
	v_add_f32 v26, v26, v38
	v_add_f32 v27, v27, v39
	s_waitcnt vmcnt(6)
	v_mfma_f32_32x32x16_bf16 v[56:71], v[128:131], v[196:199], v[56:71]
	v_add_f32 v40, v40, v244
	v_add_f32 v41, v41, v245
	v_mfma_f32_32x32x16_bf16 v[72:87], v[132:135], v[196:199], v[72:87]
	v_add_f32 v42, v42, v246
	v_add_f32 v43, v43, v247
	s_waitcnt vmcnt(5)
	v_mfma_f32_32x32x16_bf16 v[56:71], v[136:139], v[200:203], v[56:71]
	v_add_f32 v40, v40, v44
	v_add_f32 v41, v41, v45
	v_mfma_f32_32x32x16_bf16 v[72:87], v[140:143], v[200:203], v[72:87]
	v_add_f32 v42, v42, v46
	v_add_f32 v43, v43, v47
	s_waitcnt vmcnt(4)
	v_mfma_f32_32x32x16_bf16 v[56:71], v[144:147], v[204:207], v[56:71]
	v_add_f32 v40, v40, v48
	v_add_f32 v41, v41, v49
	v_mfma_f32_32x32x16_bf16 v[72:87], v[148:151], v[204:207], v[72:87]
	v_add_f32 v42, v42, v50
	v_add_f32 v43, v43, v51
	s_waitcnt vmcnt(3)
	v_mfma_f32_32x32x16_bf16 v[56:71], v[152:155], v[208:211], v[56:71]
	s_waitcnt lgkmcnt(0)
	v_add_f32 v40, v40, v52
	v_add_f32 v41, v41, v53
	v_mfma_f32_32x32x16_bf16 v[72:87], v[156:159], v[208:211], v[72:87]
	v_add_f32 v42, v42, v54
	v_add_f32 v43, v43, v55
	s_waitcnt vmcnt(2)
	v_mfma_f32_32x32x16_bf16 v[56:71], v[160:163], v[212:215], v[56:71]
	v_cvt_pk_bf16_f32 v240, v24, v40
	v_cvt_pk_bf16_f32 v241, v25, v41
	v_mfma_f32_32x32x16_bf16 v[72:87], v[164:167], v[212:215], v[72:87]
	v_cvt_pk_bf16_f32 v242, v26, v42
	v_cvt_pk_bf16_f32 v243, v27, v43
	s_waitcnt vmcnt(1)
	v_mfma_f32_32x32x16_bf16 v[56:71], v[168:171], v[232:235], v[56:71]
	buffer_store_dwordx4 v[240:243], v5, s[44:47], s84 offen
	v_mfma_f32_32x32x16_bf16 v[72:87], v[172:175], v[232:235], v[72:87]
	s_waitcnt vmcnt(1)
	v_mfma_f32_32x32x16_bf16 v[56:71], v[176:179], v[236:239], v[56:71]
	v_mfma_f32_32x32x16_bf16 v[72:87], v[180:183], v[236:239], v[72:87]
	s_nop 10
	ds_write_b128 v16, v[60:63] offset:24576
	ds_write_b128 v16, v[76:79] offset:25600
	ds_write_b128 v17, v[64:67] offset:24576
	ds_write_b128 v17, v[80:83] offset:25600
	ds_write_b128 v18, v[68:71] offset:24576
	ds_write_b128 v18, v[84:87] offset:25600
	s_waitcnt lgkmcnt(0)
	s_barrier
	ds_read_b128 v[60:63], v11 offset:24576
	ds_read_b128 v[76:79], v11 offset:25600
	ds_read_b128 v[64:67], v11 offset:26624
	ds_read_b128 v[80:83], v11 offset:27648
	ds_read_b128 v[68:71], v11 offset:28672
	ds_read_b128 v[84:87], v11 offset:29696
	v_pk_add_f32 v[56:57], v[56:57], v[248:249]
	v_pk_add_f32 v[58:59], v[58:59], v[250:251]
	s_waitcnt lgkmcnt(5)
	v_pk_add_f32 v[56:57], v[56:57], v[60:61]
	v_pk_add_f32 v[58:59], v[58:59], v[62:63]
	s_waitcnt lgkmcnt(3)
	v_pk_add_f32 v[56:57], v[56:57], v[64:65]
	v_pk_add_f32 v[58:59], v[58:59], v[66:67]
	s_waitcnt lgkmcnt(1)
	v_pk_add_f32 v[56:57], v[56:57], v[68:69]
	v_pk_add_f32 v[58:59], v[58:59], v[70:71]
	v_pk_add_f32 v[72:73], v[72:73], v[252:253]
	v_pk_add_f32 v[74:75], v[74:75], v[254:255]
	v_pk_add_f32 v[72:73], v[72:73], v[76:77]
	v_pk_add_f32 v[74:75], v[74:75], v[78:79]
	v_pk_add_f32 v[72:73], v[72:73], v[80:81]
	v_pk_add_f32 v[74:75], v[74:75], v[82:83]
	s_waitcnt lgkmcnt(0)
	v_pk_add_f32 v[72:73], v[72:73], v[84:85]
	v_pk_add_f32 v[74:75], v[74:75], v[86:87]
	v_cvt_pk_bf16_f32 v248, v56, v72
	v_cvt_pk_bf16_f32 v249, v57, v73
	v_cvt_pk_bf16_f32 v250, v58, v74
	v_cvt_pk_bf16_f32 v251, v59, v75
	buffer_store_dwordx4 v[248:251], v5, s[44:47], s85 offen
	s_endpgm

sequential_preLN__spectral_gfnet__mixer_channel_mlp__prompt_kernel_nog1:
	s_add_u32 s69, s8, 0x6000
	buffer_load_dwordx4 a[224:227], v12, s[32:35], s69 offen sc1
	buffer_load_dwordx4 a[228:231], v12, s[32:35], s69 offen offset:1024 sc1
	buffer_load_dwordx4 a[232:235], v12, s[32:35], s69 offen offset:2048 sc1
	buffer_load_dwordx4 a[236:239], v12, s[32:35], s69 offen offset:3072 sc1
	s_add_u32 s69, s9, 0
	buffer_load_dwordx4 a[240:243], v12, s[32:35], s69 offen sc1
	buffer_load_dwordx4 a[244:247], v12, s[32:35], s69 offen offset:1024 sc1
	buffer_load_dwordx4 a[248:251], v12, s[32:35], s69 offen offset:2048 sc1
	buffer_load_dwordx4 a[252:255], v12, s[32:35], s69 offen offset:3072 sc1
	s_add_u32 s69, s9, 0x1000
	buffer_load_dwordx4 v[88:91], v12, s[32:35], s69 offen sc1
	buffer_load_dwordx4 v[92:95], v12, s[32:35], s69 offen offset:1024 sc1
	buffer_load_dwordx4 v[96:99], v12, s[32:35], s69 offen offset:2048 sc1
	buffer_load_dwordx4 v[100:103], v12, s[32:35], s69 offen offset:3072 sc1
	s_add_u32 s69, s9, 0x2000
	buffer_load_dwordx4 v[104:107], v12, s[32:35], s69 offen sc1
	buffer_load_dwordx4 v[108:111], v12, s[32:35], s69 offen offset:1024 sc1
	buffer_load_dwordx4 v[112:115], v12, s[32:35], s69 offen offset:2048 sc1
	buffer_load_dwordx4 v[116:119], v12, s[32:35], s69 offen offset:3072 sc1
	s_add_u32 s69, s9, 0x3000
	buffer_load_dwordx4 v[120:123], v12, s[32:35], s69 offen sc1
	buffer_load_dwordx4 v[124:127], v12, s[32:35], s69 offen offset:1024 sc1
	buffer_load_dwordx4 v[128:131], v12, s[32:35], s69 offen offset:2048 sc1
	buffer_load_dwordx4 v[132:135], v12, s[32:35], s69 offen offset:3072 sc1
	s_add_u32 s69, s9, 0x4000
	buffer_load_dwordx4 v[136:139], v12, s[32:35], s69 offen sc1
	buffer_load_dwordx4 v[140:143], v12, s[32:35], s69 offen offset:1024 sc1
	buffer_load_dwordx4 v[144:147], v12, s[32:35], s69 offen offset:2048 sc1
	buffer_load_dwordx4 v[148:151], v12, s[32:35], s69 offen offset:3072 sc1
	s_add_u32 s69, s9, 0x5000
	buffer_load_dwordx4 v[152:155], v12, s[32:35], s69 offen sc1
	buffer_load_dwordx4 v[156:159], v12, s[32:35], s69 offen offset:1024 sc1
	buffer_load_dwordx4 v[160:163], v12, s[32:35], s69 offen offset:2048 sc1
	buffer_load_dwordx4 v[164:167], v12, s[32:35], s69 offen offset:3072 sc1
	s_add_u32 s69, s9, 0x6000
	buffer_load_dwordx4 v[168:171], v12, s[32:35], s69 offen sc1
	buffer_load_dwordx4 v[172:175], v12, s[32:35], s69 offen offset:1024 sc1
	buffer_load_dwordx4 v[176:179], v12, s[32:35], s69 offen offset:2048 sc1
	buffer_load_dwordx4 v[180:183], v12, s[32:35], s69 offen offset:3072 sc1
	s_load_dwordx4 s[64:67], s[6:7], s73 glc
	s_waitcnt lgkmcnt(0)
	s_cmp_ge_u32 s64, 7
	s_cbranch_scc1 sequential_preLN__spectral_gfnet__mixer_channel_mlp__prompt_kernel_donec0
	s_mov_b32 s62, 0x80000
sequential_preLN__spectral_gfnet__mixer_channel_mlp__prompt_kernel_pollc0:
	s_load_dwordx4 s[64:67], s[6:7], s73 glc
	s_waitcnt lgkmcnt(0)
	s_cmp_ge_u32 s64, 7
	s_cbranch_scc1 sequential_preLN__spectral_gfnet__mixer_channel_mlp__prompt_kernel_donec0
	s_sub_u32 s62, s62, 1
	s_cmp_lg_u32 s62, 0
	s_cbranch_scc1 sequential_preLN__spectral_gfnet__mixer_channel_mlp__prompt_kernel_pollc0
sequential_preLN__spectral_gfnet__mixer_channel_mlp__prompt_kernel_donec0:
	s_add_u32 s16, s74, 0
	buffer_load_dwordx4 a[0:3], v6, s[52:55], s16 offen sc1
	buffer_load_dwordx4 a[4:7], v6, s[52:55], s16 offen offset:1024 sc1
	buffer_load_dwordx4 a[8:11], v6, s[52:55], s16 offen offset:2048 sc1
	buffer_load_dwordx4 a[12:15], v6, s[52:55], s16 offen offset:3072 sc1
	s_add_u32 s16, s74, 0x1000
	buffer_load_dwordx4 a[16:19], v6, s[52:55], s16 offen sc1
	buffer_load_dwordx4 a[20:23], v6, s[52:55], s16 offen offset:1024 sc1
	buffer_load_dwordx4 a[24:27], v6, s[52:55], s16 offen offset:2048 sc1
	buffer_load_dwordx4 a[28:31], v6, s[52:55], s16 offen offset:3072 sc1
	s_add_u32 s16, s74, 0x2000
	buffer_load_dwordx4 a[32:35], v6, s[52:55], s16 offen sc1
	buffer_load_dwordx4 a[36:39], v6, s[52:55], s16 offen offset:1024 sc1
	buffer_load_dwordx4 a[40:43], v6, s[52:55], s16 offen offset:2048 sc1
	buffer_load_dwordx4 a[44:47], v6, s[52:55], s16 offen offset:3072 sc1
	s_add_u32 s16, s74, 0x3000
	buffer_load_dwordx4 a[48:51], v6, s[52:55], s16 offen sc1
	buffer_load_dwordx4 a[52:55], v6, s[52:55], s16 offen offset:1024 sc1
	s_load_dwordx4 s[64:67], s[6:7], s73 glc
	s_waitcnt lgkmcnt(0)
	s_cmp_ge_u32 s65, 7
	s_cbranch_scc1 sequential_preLN__spectral_gfnet__mixer_channel_mlp__prompt_kernel_donec1
	s_mov_b32 s62, 0x80000
sequential_preLN__spectral_gfnet__mixer_channel_mlp__prompt_kernel_pollc1:
	s_load_dwordx4 s[64:67], s[6:7], s73 glc
	s_waitcnt lgkmcnt(0)
	s_cmp_ge_u32 s65, 7
	s_cbranch_scc1 sequential_preLN__spectral_gfnet__mixer_channel_mlp__prompt_kernel_donec1
	s_sub_u32 s62, s62, 1
	s_cmp_lg_u32 s62, 0
	s_cbranch_scc1 sequential_preLN__spectral_gfnet__mixer_channel_mlp__prompt_kernel_pollc1
sequential_preLN__spectral_gfnet__mixer_channel_mlp__prompt_kernel_donec1:
	s_add_u32 s16, s75, 0
	buffer_load_dwordx4 a[56:59], v6, s[52:55], s16 offen sc1
	buffer_load_dwordx4 a[60:63], v6, s[52:55], s16 offen offset:1024 sc1
	buffer_load_dwordx4 a[64:67], v6, s[52:55], s16 offen offset:2048 sc1
	buffer_load_dwordx4 a[68:71], v6, s[52:55], s16 offen offset:3072 sc1
	s_add_u32 s16, s75, 0x1000
	buffer_load_dwordx4 a[72:75], v6, s[52:55], s16 offen sc1
	buffer_load_dwordx4 a[76:79], v6, s[52:55], s16 offen offset:1024 sc1
	buffer_load_dwordx4 a[80:83], v6, s[52:55], s16 offen offset:2048 sc1
	buffer_load_dwordx4 a[84:87], v6, s[52:55], s16 offen offset:3072 sc1
	s_add_u32 s16, s75, 0x2000
	buffer_load_dwordx4 a[88:91], v6, s[52:55], s16 offen sc1
	buffer_load_dwordx4 a[92:95], v6, s[52:55], s16 offen offset:1024 sc1
	buffer_load_dwordx4 a[96:99], v6, s[52:55], s16 offen offset:2048 sc1
	buffer_load_dwordx4 a[100:103], v6, s[52:55], s16 offen offset:3072 sc1
	s_add_u32 s16, s75, 0x3000
	buffer_load_dwordx4 a[104:107], v6, s[52:55], s16 offen sc1
	buffer_load_dwordx4 a[108:111], v6, s[52:55], s16 offen offset:1024 sc1
	s_waitcnt vmcnt(27)
	v_mfma_f32_32x32x16_bf16 v[24:39], a[128:131], a[0:3], 0
	v_mfma_f32_32x32x16_bf16 v[40:55], a[132:135], a[0:3], 0
	s_waitcnt vmcnt(26)
	v_mfma_f32_32x32x16_bf16 v[24:39], a[136:139], a[4:7], v[24:39]
	v_mfma_f32_32x32x16_bf16 v[40:55], a[140:143], a[4:7], v[40:55]
	s_waitcnt vmcnt(25)
	v_mfma_f32_32x32x16_bf16 v[24:39], a[144:147], a[8:11], v[24:39]
	v_mfma_f32_32x32x16_bf16 v[40:55], a[148:151], a[8:11], v[40:55]
	s_waitcnt vmcnt(24)
	v_mfma_f32_32x32x16_bf16 v[24:39], a[152:155], a[12:15], v[24:39]
	v_mfma_f32_32x32x16_bf16 v[40:55], a[156:159], a[12:15], v[40:55]
	s_waitcnt vmcnt(23)
	v_mfma_f32_32x32x16_bf16 v[24:39], a[160:163], a[16:19], v[24:39]
	v_mfma_f32_32x32x16_bf16 v[40:55], a[164:167], a[16:19], v[40:55]
	s_waitcnt vmcnt(22)
	v_mfma_f32_32x32x16_bf16 v[24:39], a[168:171], a[20:23], v[24:39]
	v_mfma_f32_32x32x16_bf16 v[40:55], a[172:175], a[20:23], v[40:55]
	s_waitcnt vmcnt(21)
	v_mfma_f32_32x32x16_bf16 v[24:39], a[176:179], a[24:27], v[24:39]
	v_mfma_f32_32x32x16_bf16 v[40:55], a[180:183], a[24:27], v[40:55]
	s_waitcnt vmcnt(20)
	v_mfma_f32_32x32x16_bf16 v[24:39], a[184:187], a[28:31], v[24:39]
	v_mfma_f32_32x32x16_bf16 v[40:55], a[188:191], a[28:31], v[40:55]
	s_waitcnt vmcnt(19)
	v_mfma_f32_32x32x16_bf16 v[24:39], a[192:195], a[32:35], v[24:39]
	v_mfma_f32_32x32x16_bf16 v[40:55], a[196:199], a[32:35], v[40:55]
	s_waitcnt vmcnt(18)
	v_mfma_f32_32x32x16_bf16 v[24:39], a[200:203], a[36:39], v[24:39]
	v_mfma_f32_32x32x16_bf16 v[40:55], a[204:207], a[36:39], v[40:55]
	s_waitcnt vmcnt(17)
	v_mfma_f32_32x32x16_bf16 v[24:39], a[208:211], a[40:43], v[24:39]
	v_mfma_f32_32x32x16_bf16 v[40:55], a[212:215], a[40:43], v[40:55]
	s_waitcnt vmcnt(16)
	v_mfma_f32_32x32x16_bf16 v[24:39], a[216:219], a[44:47], v[24:39]
	buffer_load_dwordx4 v[216:219], v4, s[36:39], s80 offen sc1
	v_mfma_f32_32x32x16_bf16 v[40:55], a[220:223], a[44:47], v[40:55]
	s_waitcnt vmcnt(16)
	v_mfma_f32_32x32x16_bf16 v[24:39], a[224:227], a[48:51], v[24:39]
	buffer_load_dwordx4 v[220:223], v4, s[36:39], s81 offen sc1
	v_mfma_f32_32x32x16_bf16 v[40:55], a[228:231], a[48:51], v[40:55]
	s_load_dwordx4 s[64:67], s[6:7], s73 glc
	s_waitcnt vmcnt(16)
	v_mfma_f32_32x32x16_bf16 v[24:39], a[232:235], a[52:55], v[24:39]
	buffer_load_dwordx4 v[224:227], v10, s[48:51], s76 offen
	v_mfma_f32_32x32x16_bf16 v[40:55], a[236:239], a[52:55], v[40:55]
	s_waitcnt vmcnt(0)
	s_branch sequential_preLN__spectral_gfnet__mixer_channel_mlp__prompt_kernel_g2
	s_endpgm

sequential_preLN__spectral_gfnet__mixer_channel_mlp__prompt_kernel_helper:
	s_and_b32 s60, s2, 7
	s_lshl_b32 s80, s60, 4
	s_add_u32 s80, s80, s27
	s_waitcnt lgkmcnt(0)
	s_mov_b32 s36, s22
	s_mov_b32 s37, s23
	s_mov_b32 s38, 0x100
	s_mov_b32 s39, 0x20000
	s_add_u32 s28, s24, 0x1490000
	s_addc_u32 s29, s25, 0
	s_mov_b32 s30, 0x38000
	s_mov_b32 s31, 0x20000
	s_cmp_ge_u32 s3, 2
	s_cbranch_scc1 sequential_preLN__spectral_gfnet__mixer_channel_mlp__prompt_kernel_hw2
	s_lshr_b32 s81, s80, 2
	s_and_b32 s82, s80, 3
	s_lshl_b32 s60, s81, 1
	s_lshl_b32 s61, s82, 8
	s_add_u32 s60, s60, s61
	s_add_u32 s60, s60, s3
	s_mul_i32 s84, s60, 0x202
	v_lshlrev_b32 v24, 3, v1
	v_mov_b32 v25, 0x200
	s_mov_b32 s52, s6
	s_mov_b32 s53, s7
	s_mov_b32 s54, 0x101000
	s_mov_b32 s55, 0x20000
	s_mov_b32 s56, s8
	s_mov_b32 s57, s9
	s_mov_b32 s58, 0x101000
	s_mov_b32 s59, 0x20000
	s_add_u32 s85, s84, 0
	buffer_load_dwordx2 v[34:35], v24, s[52:55], s85 offen
	buffer_load_dwordx2 v[50:51], v24, s[56:59], s85 offen
	s_add_u32 s85, s84, 0x8080
	buffer_load_dwordx2 v[36:37], v24, s[52:55], s85 offen
	buffer_load_dwordx2 v[52:53], v24, s[56:59], s85 offen
	s_add_u32 s85, s84, 0x10100
	buffer_load_dwordx2 v[38:39], v24, s[52:55], s85 offen
	buffer_load_dwordx2 v[54:55], v24, s[56:59], s85 offen
	s_add_u32 s85, s84, 0x18180
	buffer_load_dwordx2 v[40:41], v24, s[52:55], s85 offen
	buffer_load_dwordx2 v[56:57], v24, s[56:59], s85 offen
	s_add_u32 s85, s84, 0x80800
	buffer_load_dwordx2 v[42:43], v24, s[52:55], s85 offen
	buffer_load_dwordx2 v[58:59], v24, s[56:59], s85 offen
	s_add_u32 s85, s84, 0x88880
	buffer_load_dwordx2 v[44:45], v24, s[52:55], s85 offen
	buffer_load_dwordx2 v[60:61], v24, s[56:59], s85 offen
	s_add_u32 s85, s84, 0x90900
	buffer_load_dwordx2 v[46:47], v24, s[52:55], s85 offen
	buffer_load_dwordx2 v[62:63], v24, s[56:59], s85 offen
	s_add_u32 s85, s84, 0x98980
	buffer_load_dwordx2 v[48:49], v24, s[52:55], s85 offen
	buffer_load_dwordx2 v[64:65], v24, s[56:59], s85 offen
	s_mov_b64 exec, 1
	s_add_u32 s85, s84, 0
	buffer_load_ushort v66, v25, s[52:55], s85 offen
	buffer_load_ushort v74, v25, s[56:59], s85 offen
	s_add_u32 s85, s84, 0x8080
	buffer_load_ushort v67, v25, s[52:55], s85 offen
	buffer_load_ushort v75, v25, s[56:59], s85 offen
	s_add_u32 s85, s84, 0x10100
	buffer_load_ushort v68, v25, s[52:55], s85 offen
	buffer_load_ushort v76, v25, s[56:59], s85 offen
	s_add_u32 s85, s84, 0x18180
	buffer_load_ushort v69, v25, s[52:55], s85 offen
	buffer_load_ushort v77, v25, s[56:59], s85 offen
	s_add_u32 s85, s84, 0x80800
	buffer_load_ushort v70, v25, s[52:55], s85 offen
	buffer_load_ushort v78, v25, s[56:59], s85 offen
	s_add_u32 s85, s84, 0x88880
	buffer_load_ushort v71, v25, s[52:55], s85 offen
	buffer_load_ushort v79, v25, s[56:59], s85 offen
	s_add_u32 s85, s84, 0x90900
	buffer_load_ushort v72, v25, s[52:55], s85 offen
	buffer_load_ushort v80, v25, s[56:59], s85 offen
	s_add_u32 s85, s84, 0x98980
	buffer_load_ushort v73, v25, s[52:55], s85 offen
	buffer_load_ushort v81, v25, s[56:59], s85 offen
	s_mov_b64 exec, -1
	s_add_u32 s40, s24, 0x208000
	s_addc_u32 s41, s25, 0
	s_mov_b32 s42, 0x204000
	s_mov_b32 s43, 0x20000
	s_lshr_b32 s60, s81, 3
	s_lshl_b32 s83, s60, 12
	s_and_b32 s60, s81, 7
	s_lshl_b32 s61, s82, 3
	s_add_u32 s60, s60, s61
	s_lshl_b32 s60, s60, 7
	s_add_u32 s83, s83, s60
	v_lshrrev_b32 v2, 3, v1
	s_lshl_b32 s60, s3, 6
	v_add_u32 v2, s60, v2
	v_and_b32 v3, 7, v1
	v_lshlrev_b32 v32, 4, v3
	v_lshl_add_u32 v32, v2, 14, v32
	v_lshrrev_b32 v31, 1, v2
	v_xor_b32 v3, v3, v31
	v_and_b32 v3, 7, v3
	v_lshlrev_b32 v3, 4, v3
	v_lshl_add_u32 v31, v2, 7, v3
	v_add_u32 v31, 0x20000, v31
	v_and_b32 v2, 7, v1
	s_lshl_b32 s60, s3, 1
	v_xor_b32 v3, s60, v2
	v_xor_b32 v3, 0, v3
	v_lshlrev_b32 v3, 4, v3
	v_lshl_add_u32 v26, v1, 8, v3
	v_add_u32 v26, 0x20000, v26
	v_xor_b32 v3, s60, v2
	v_xor_b32 v3, 1, v3
	v_lshlrev_b32 v3, 4, v3
	v_lshl_add_u32 v27, v1, 8, v3
	v_add_u32 v27, 0x20000, v27
	v_xor_b32 v3, s60, v2
	v_xor_b32 v3, 4, v3
	v_lshlrev_b32 v3, 4, v3
	v_lshl_add_u32 v28, v1, 8, v3
	v_add_u32 v28, 0x20000, v28
	v_xor_b32 v3, s60, v2
	v_xor_b32 v3, 5, v3
	v_lshlrev_b32 v3, 4, v3
	v_lshl_add_u32 v29, v1, 8, v3
	v_add_u32 v29, 0x20000, v29
	s_lshl_b32 s60, s3, 5
	s_add_u32 s60, s60, 0x24000
	v_mov_b32 v30, s60
	s_mov_b32 s81, 0x5040100
	s_mov_b32 s82, 0x7060302
	s_lshr_b32 s60, s2, 7
	s_mul_i32 s60, s60, 14
	s_add_u32 s60, s60, s27
	s_mul_i32 s77, s60, 37
	s_lshr_b32 s77, s77, 8
	s_mul_i32 s61, s77, 7
	s_sub_u32 s78, s60, s61
	s_and_b32 s60, s2, 1
	s_mul_i32 s60, s60, 7
	s_add_u32 s78, s78, s60
	s_bfe_u32 s60, s2, 0x20001
	s_lshl_b32 s60, s60, 2
	s_add_u32 s77, s77, s60
	v_mov_b32 v9, 1
	v_lshlrev_b32 v6, 4, v1
	v_lshrrev_b32 v2, 4, v1
	v_mul_u32_u24 v11, 0xe00, v2
	v_lshlrev_b32 v2, 2, v2
	v_and_b32 v3, 15, v1
	v_xor_b32 v2, v2, v3
	v_lshl_add_u32 v11, v2, 4, v11
	s_lshl_b32 s60, s3, 7
	v_xor_b32 v12, s60, v6
	s_lshr_b32 s70, s27, 3
	s_mul_i32 s63, s3, 0x3800
	s_lshl_b32 s60, s78, 8
	s_add_u32 s63, s63, s60
	s_lshl_b32 s68, s3, 10
	s_lshl_b32 s79, s77, 4
	s_add_u32 s79, s79, s78
	s_lshl_b32 s79, s79, 7
	v_mov_b32 v2, 0x10000000
	v_cmp_gt_u32 vcc, 16, v1
	v_lshlrev_b32 v3, 7, v1
	s_nop 0
	v_cndmask_b32 v8, v2, v3, vcc
	v_cmp_gt_u32 vcc, 8, v1
	v_lshlrev_b32 v3, 9, v1
	s_nop 0
	v_cndmask_b32 v7, v2, v3, vcc
	v_lshrrev_b32 v2, 5, v1
	v_lshlrev_b32 v10, 3, v2
	s_lshl_b32 s71, s26, 4
	s_add_u32 s71, s71, s27
	s_lshl_b32 s71, s71, 7
	s_lshl_b32 s72, s26, 2
	s_lshl_b32 s60, s70, 1
	s_add_u32 s72, s72, s60
	s_lshl_b32 s60, s72, 2
	s_add_u32 s60, s60, s3
	s_lshl_b32 s60, s60, 1
	s_add_u32 s60, s60, s70
	s_mul_i32 s74, s60, 0x3800
	s_xor_b32 s61, s70, 1
	s_lshl_b32 s60, s72, 2
	s_add_u32 s60, s60, s3
	s_lshl_b32 s60, s60, 1
	s_add_u32 s60, s60, s61
	s_mul_i32 s75, s60, 0x3800
	s_lshl_b32 s73, s71, 2
	s_lshl_b32 s60, s3, 7
	s_add_u32 s73, s73, s60
	s_add_u32 s73, s73, 0x8000
	s_add_u32 s28, s24, 0x1490000
	s_addc_u32 s29, s25, 0
	s_mov_b32 s30, 0x38000
	s_mov_b32 s31, 0x20000
	s_add_u32 s32, s24, 0xbd0000
	s_addc_u32 s33, s25, 0
	s_mov_b32 s34, 0x1c0000
	s_mov_b32 s35, 0x20000
	s_mov_b32 s44, s12
	s_mov_b32 s45, s13
	s_mov_b32 s46, 0x1c0000
	s_mov_b32 s47, 0x20000
	s_cmp_ge_u32 s27, 14
	s_cselect_b32 s46, 0, 0x1c0000
	s_and_b32 s60, s77, 1
	s_mul_i32 s61, s60, 0xe0000
	s_add_u32 s63, s63, s61
	s_lshl_b32 s61, s60, 16
	s_add_u32 s68, s68, s61
	s_mul_i32 s23, s60, 0x1c0000
	s_mov_b32 s10, s14
	s_mov_b32 s11, s15
	s_mov_b32 s6, s28
	s_mov_b32 s7, s29
	s_mul_i32 s60, s70, 0x7000
	s_add_u32 s8, s69, s60
	s_xor_b32 s60, s70, 1
	s_mul_i32 s60, s60, 0x7000
	s_add_u32 s9, s69, s60
	s_waitcnt vmcnt(30)
	v_perm_b32 v82, v50, v34, s81
	s_waitcnt vmcnt(28)
	v_perm_b32 v83, v52, v36, s81
	s_waitcnt vmcnt(26)
	v_perm_b32 v84, v54, v38, s81
	s_waitcnt vmcnt(24)
	v_perm_b32 v85, v56, v40, s81
	s_waitcnt vmcnt(22)
	v_perm_b32 v86, v58, v42, s81
	s_waitcnt vmcnt(20)
	v_perm_b32 v87, v60, v44, s81
	s_waitcnt vmcnt(18)
	v_perm_b32 v88, v62, v46, s81
	s_waitcnt vmcnt(16)
	v_perm_b32 v89, v64, v48, s81
	ds_write_b128 v26, v[82:85]
	ds_write_b128 v27, v[86:89]
	s_mov_b64 exec, 1
	ds_write_b128 v30, v[82:85]
	ds_write_b128 v30, v[86:89] offset:16
	s_mov_b64 exec, -1
	v_perm_b32 v90, v50, v34, s82
	v_perm_b32 v91, v52, v36, s82
	v_perm_b32 v92, v54, v38, s82
	v_perm_b32 v93, v56, v40, s82
	v_perm_b32 v94, v58, v42, s82
	v_perm_b32 v95, v60, v44, s82
	v_perm_b32 v96, v62, v46, s82
	v_perm_b32 v97, v64, v48, s82
	ds_write_b128 v28, v[90:93]
	ds_write_b128 v29, v[94:97]
	v_perm_b32 v82, v51, v35, s81
	v_perm_b32 v83, v53, v37, s81
	v_perm_b32 v84, v55, v39, s81
	v_perm_b32 v85, v57, v41, s81
	v_perm_b32 v86, v59, v43, s81
	v_perm_b32 v87, v61, v45, s81
	v_perm_b32 v88, v63, v47, s81
	v_perm_b32 v89, v65, v49, s81
	ds_write_b128 v26, v[82:85] offset:128
	ds_write_b128 v27, v[86:89] offset:128
	v_perm_b32 v90, v51, v35, s82
	v_perm_b32 v91, v53, v37, s82
	v_perm_b32 v92, v55, v39, s82
	v_perm_b32 v93, v57, v41, s82
	v_perm_b32 v94, v59, v43, s82
	v_perm_b32 v95, v61, v45, s82
	v_perm_b32 v96, v63, v47, s82
	v_perm_b32 v97, v65, v49, s82
	ds_write_b128 v28, v[90:93] offset:128
	ds_write_b128 v29, v[94:97] offset:128
	s_mov_b64 exec, 1
	s_waitcnt vmcnt(14)
	v_lshl_or_b32 v66, v74, 16, v66
	s_waitcnt vmcnt(12)
	v_lshl_or_b32 v67, v75, 16, v67
	s_waitcnt vmcnt(10)
	v_lshl_or_b32 v68, v76, 16, v68
	s_waitcnt vmcnt(8)
	v_lshl_or_b32 v69, v77, 16, v69
	s_waitcnt vmcnt(6)
	v_lshl_or_b32 v70, v78, 16, v70
	s_waitcnt vmcnt(4)
	v_lshl_or_b32 v71, v79, 16, v71
	s_waitcnt vmcnt(2)
	v_lshl_or_b32 v72, v80, 16, v72
	s_waitcnt vmcnt(0)
	v_lshl_or_b32 v73, v81, 16, v73
	ds_write_b128 v30, v[66:69] offset:64
	ds_write_b128 v30, v[70:73] offset:80
	s_mov_b64 exec, -1
	s_waitcnt lgkmcnt(0)
	s_barrier
	v_xor_b32 v24, 64, v31
	ds_read_b128 v[98:101], v31
	ds_read_b128 v[102:105], v24 offset:1024
	ds_read_b128 v[106:109], v31 offset:2048
	ds_read_b128 v[110:113], v24 offset:3072
	ds_read_b128 v[114:117], v31 offset:4096
	ds_read_b128 v[118:121], v24 offset:5120
	ds_read_b128 v[122:125], v31 offset:6144
	ds_read_b128 v[126:129], v24 offset:7168
	v_and_b32 v2, 7, v1
	v_lshlrev_b32 v2, 4, v2
	v_add_u32 v3, 0x24000, v2
	ds_read_b128 v[130:133], v3
	s_waitcnt lgkmcnt(8)
	buffer_store_dwordx4 v[98:101], v32, s[40:43], s83 offen sc1
	s_add_u32 s60, s83, 0x20000
	s_waitcnt lgkmcnt(7)
	buffer_store_dwordx4 v[102:105], v32, s[40:43], s60 offen sc1
	s_add_u32 s60, s83, 0x40000
	s_waitcnt lgkmcnt(6)
	buffer_store_dwordx4 v[106:109], v32, s[40:43], s60 offen sc1
	s_add_u32 s60, s83, 0x60000
	s_waitcnt lgkmcnt(5)
	buffer_store_dwordx4 v[110:113], v32, s[40:43], s60 offen sc1
	s_add_u32 s60, s83, 0x80000
	s_waitcnt lgkmcnt(4)
	buffer_store_dwordx4 v[114:117], v32, s[40:43], s60 offen sc1
	s_add_u32 s60, s83, 0xa0000
	s_waitcnt lgkmcnt(3)
	buffer_store_dwordx4 v[118:121], v32, s[40:43], s60 offen sc1
	s_add_u32 s60, s83, 0xc0000
	s_waitcnt lgkmcnt(2)
	buffer_store_dwordx4 v[122:125], v32, s[40:43], s60 offen sc1
	s_add_u32 s60, s83, 0xe0000
	s_waitcnt lgkmcnt(1)
	buffer_store_dwordx4 v[126:129], v32, s[40:43], s60 offen sc1
	s_cmp_eq_u32 s3, 0
	s_cselect_b32 s60, 8, 0
	v_mov_b32 v3, 0x10000000
	v_cmp_gt_u32 vcc, s60, v1
	s_nop 1
	v_cndmask_b32 v2, v3, v2, vcc
	s_add_u32 s60, s83, 0x200000
	s_waitcnt lgkmcnt(0)
	buffer_store_dwordx4 v[130:133], v2, s[40:43], s60 offen sc1
	s_branch sequential_preLN__spectral_gfnet__mixer_channel_mlp__prompt_kernel_hrb

sequential_preLN__spectral_gfnet__mixer_channel_mlp__prompt_kernel_hw2:
	v_mov_b32 v24, 0
	v_mov_b32 v25, 0
	v_mov_b32 v26, 0
	v_mov_b32 v27, 0
	s_and_b32 s60, s80, 3
	s_xor_b32 s61, s3, 3
	s_or_b32 s52, s60, s61
	s_cmp_eq_u32 s52, 0
	s_cselect_b32 s52, 0, 0x10000000
	v_lshlrev_b32 v28, 4, v1
	v_or_b32 v2, s52, v28
	s_lshr_b32 s60, s80, 2
	s_lshl_b32 s60, s60, 10
	s_add_u32 s60, s60, 0x30000
	buffer_store_dwordx4 v[24:27], v2, s[28:31], s60 offen sc1
	s_cmp_eq_u32 s3, 2
	s_cselect_b32 s61, 0, 0x10000000
	v_or_b32 v28, s61, v28
	v_mov_b32 v3, 0x10000000
	v_cmp_gt_u32 vcc, 32, v1
	s_nop 1
	v_cndmask_b32 v2, v3, v28, vcc
	s_mul_i32 s60, s80, 0x600
	buffer_store_dwordx4 v[24:27], v28, s[28:31], s60 offen sc1
	buffer_store_dwordx4 v[24:27], v2, s[28:31], s60 offen offset:1024 sc1
	v_lshrrev_b32 v29, 5, v1
	v_and_b32 v30, 31, v1
	v_lshlrev_b32 v30, 2, v30
	v_lshl_add_u32 v29, v29, 12, v30
	v_lshlrev_b32 v30, 4, v1
	s_mov_b32 s48, s16
	s_mov_b32 s49, s17
	s_mov_b32 s50, 0x1c0000
	s_mov_b32 s51, 0x20000
	s_bfe_u32 s60, s80, 0x10001
	s_lshl_b32 s53, s60, 17
	s_bfe_u32 s60, s80, 0x20002
	s_lshl_b32 s60, s60, 15
	s_add_u32 s53, s53, s60
	s_lshr_b32 s60, s80, 4
	s_lshl_b32 s60, s60, 7
	s_add_u32 s53, s53, s60
	s_and_b32 s54, s80, 1
	s_mul_i32 s54, s54, 7
	s_and_b32 s61, s3, 1
	s_lshl_b32 s60, s61, 2
	s_add_u32 s54, s54, s60
	s_lshr_b32 s55, s80, 1
	s_mul_i32 s55, s55, 14
	s_add_u32 s55, s55, s54
	s_lshl_b32 s55, s55, 11
	s_cmp_lg_u32 s52, 0
	s_cbranch_scc1 sequential_preLN__spectral_gfnet__mixer_channel_mlp__prompt_kernel_ncl
	s_waitcnt vmcnt(2)
	v_mov_b32 v28, 0
	s_mov_b64 exec, 1
	v_mov_b32 v3, 1
	buffer_atomic_add v3, v28, s[36:39], 0 offen sc0 sc1
	s_mov_b64 exec, -1
sequential_preLN__spectral_gfnet__mixer_channel_mlp__prompt_kernel_ncl:
	s_add_u32 s57, s54, 0
	s_lshr_b32 s56, s57, 1
	s_lshl_b32 s56, s56, 18
	s_and_b32 s57, s57, 1
	s_lshl_b32 s57, s57, 14
	s_add_u32 s56, s56, s57
	s_add_u32 s56, s56, s53
	s_add_u32 s57, s56, 0x2000
	buffer_load_dword v32, v29, s[48:51], s56 offen
	buffer_load_dword v33, v29, s[48:51], s56 offen offset:1024
	buffer_load_dword v34, v29, s[48:51], s56 offen offset:2048
	buffer_load_dword v35, v29, s[48:51], s56 offen offset:3072
	buffer_load_dword v36, v29, s[48:51], s57 offen
	buffer_load_dword v37, v29, s[48:51], s57 offen offset:1024
	buffer_load_dword v38, v29, s[48:51], s57 offen offset:2048
	buffer_load_dword v39, v29, s[48:51], s57 offen offset:3072
	s_add_u32 s57, s54, 1
	s_lshr_b32 s56, s57, 1
	s_lshl_b32 s56, s56, 18
	s_and_b32 s57, s57, 1
	s_lshl_b32 s57, s57, 14
	s_add_u32 s56, s56, s57
	s_add_u32 s56, s56, s53
	s_add_u32 s57, s56, 0x2000
	buffer_load_dword v40, v29, s[48:51], s56 offen
	buffer_load_dword v41, v29, s[48:51], s56 offen offset:1024
	buffer_load_dword v42, v29, s[48:51], s56 offen offset:2048
	buffer_load_dword v43, v29, s[48:51], s56 offen offset:3072
	buffer_load_dword v44, v29, s[48:51], s57 offen
	buffer_load_dword v45, v29, s[48:51], s57 offen offset:1024
	buffer_load_dword v46, v29, s[48:51], s57 offen offset:2048
	buffer_load_dword v47, v29, s[48:51], s57 offen offset:3072
	s_add_u32 s57, s54, 2
	s_lshr_b32 s56, s57, 1
	s_lshl_b32 s56, s56, 18
	s_and_b32 s57, s57, 1
	s_lshl_b32 s57, s57, 14
	s_add_u32 s56, s56, s57
	s_add_u32 s56, s56, s53
	s_add_u32 s57, s56, 0x2000
	buffer_load_dword v48, v29, s[48:51], s56 offen
	buffer_load_dword v49, v29, s[48:51], s56 offen offset:1024
	buffer_load_dword v50, v29, s[48:51], s56 offen offset:2048
	buffer_load_dword v51, v29, s[48:51], s56 offen offset:3072
	buffer_load_dword v52, v29, s[48:51], s57 offen
	buffer_load_dword v53, v29, s[48:51], s57 offen offset:1024
	buffer_load_dword v54, v29, s[48:51], s57 offen offset:2048
	buffer_load_dword v55, v29, s[48:51], s57 offen offset:3072
	s_add_u32 s57, s54, 3
	s_sub_u32 s57, s57, s61
	s_lshr_b32 s56, s57, 1
	s_lshl_b32 s56, s56, 18
	s_and_b32 s57, s57, 1
	s_lshl_b32 s57, s57, 14
	s_add_u32 s56, s56, s57
	s_add_u32 s56, s56, s53
	s_add_u32 s57, s56, 0x2000
	buffer_load_dword v56, v29, s[48:51], s56 offen
	buffer_load_dword v57, v29, s[48:51], s56 offen offset:1024
	buffer_load_dword v58, v29, s[48:51], s56 offen offset:2048
	buffer_load_dword v59, v29, s[48:51], s56 offen offset:3072
	buffer_load_dword v60, v29, s[48:51], s57 offen
	buffer_load_dword v61, v29, s[48:51], s57 offen offset:1024
	buffer_load_dword v62, v29, s[48:51], s57 offen offset:2048
	buffer_load_dword v63, v29, s[48:51], s57 offen offset:3072
	s_cmp_lg_u32 s52, 0
	s_cbranch_scc1 sequential_preLN__spectral_gfnet__mixer_channel_mlp__prompt_kernel_ncl2
	s_waitcnt vmcnt(32)
	v_readfirstlane_b32 s60, v3
	s_nop 1
	s_cmp_lg_u32 s60, 31
	s_cbranch_scc1 sequential_preLN__spectral_gfnet__mixer_channel_mlp__prompt_kernel_ncl2
	s_mov_b64 exec, 1
	v_mov_b32 v3, 1
	buffer_store_dword v3, v28, s[36:39], 0 offen offset:128 sc1
	s_mov_b64 exec, -1
sequential_preLN__spectral_gfnet__mixer_channel_mlp__prompt_kernel_ncl2:
	s_add_u32 s32, s24, 0xbd0000
	s_addc_u32 s33, s25, 0
	s_mov_b32 s34, 0x1c0000
	s_mov_b32 s35, 0x20000
	s_lshl_b32 s54, s61, 11
	s_lshr_b32 s60, s2, 7
	s_mul_i32 s60, s60, 14
	s_add_u32 s60, s60, s27
	s_mul_i32 s77, s60, 37
	s_lshr_b32 s77, s77, 8
	s_mul_i32 s61, s77, 7
	s_sub_u32 s78, s60, s61
	s_and_b32 s60, s2, 1
	s_mul_i32 s60, s60, 7
	s_add_u32 s78, s78, s60
	s_bfe_u32 s60, s2, 0x20001
	s_lshl_b32 s60, s60, 2
	s_add_u32 s77, s77, s60
	v_mov_b32 v9, 1
	v_lshlrev_b32 v6, 4, v1
	v_lshrrev_b32 v2, 4, v1
	v_mul_u32_u24 v11, 0xe00, v2
	v_lshlrev_b32 v2, 2, v2
	v_and_b32 v3, 15, v1
	v_xor_b32 v2, v2, v3
	v_lshl_add_u32 v11, v2, 4, v11
	s_lshl_b32 s60, s3, 7
	v_xor_b32 v12, s60, v6
	s_lshr_b32 s70, s27, 3
	s_mul_i32 s63, s3, 0x3800
	s_lshl_b32 s60, s78, 8
	s_add_u32 s63, s63, s60
	s_lshl_b32 s68, s3, 10
	s_lshl_b32 s79, s77, 4
	s_add_u32 s79, s79, s78
	s_lshl_b32 s79, s79, 7
	v_mov_b32 v2, 0x10000000
	v_cmp_gt_u32 vcc, 16, v1
	v_lshlrev_b32 v3, 7, v1
	s_nop 0
	v_cndmask_b32 v8, v2, v3, vcc
	v_cmp_gt_u32 vcc, 8, v1
	v_lshlrev_b32 v3, 9, v1
	s_nop 0
	v_cndmask_b32 v7, v2, v3, vcc
	v_lshrrev_b32 v2, 5, v1
	v_lshlrev_b32 v10, 3, v2
	s_lshl_b32 s71, s26, 4
	s_add_u32 s71, s71, s27
	s_lshl_b32 s71, s71, 7
	s_lshl_b32 s72, s26, 2
	s_lshl_b32 s60, s70, 1
	s_add_u32 s72, s72, s60
	s_lshl_b32 s60, s72, 2
	s_add_u32 s60, s60, s3
	s_lshl_b32 s60, s60, 1
	s_add_u32 s60, s60, s70
	s_mul_i32 s74, s60, 0x3800
	s_xor_b32 s61, s70, 1
	s_lshl_b32 s60, s72, 2
	s_add_u32 s60, s60, s3
	s_lshl_b32 s60, s60, 1
	s_add_u32 s60, s60, s61
	s_mul_i32 s75, s60, 0x3800
	s_lshl_b32 s73, s71, 2
	s_lshl_b32 s60, s3, 7
	s_add_u32 s73, s73, s60
	s_add_u32 s73, s73, 0x8000
	s_add_u32 s28, s24, 0x1490000
	s_addc_u32 s29, s25, 0
	s_mov_b32 s30, 0x38000
	s_mov_b32 s31, 0x20000
	s_add_u32 s32, s24, 0xbd0000
	s_addc_u32 s33, s25, 0
	s_mov_b32 s34, 0x1c0000
	s_mov_b32 s35, 0x20000
	s_mov_b32 s44, s12
	s_mov_b32 s45, s13
	s_mov_b32 s46, 0x1c0000
	s_mov_b32 s47, 0x20000
	s_cmp_ge_u32 s27, 14
	s_cselect_b32 s46, 0, 0x1c0000
	s_and_b32 s60, s77, 1
	s_mul_i32 s61, s60, 0xe0000
	s_add_u32 s63, s63, s61
	s_lshl_b32 s61, s60, 16
	s_add_u32 s68, s68, s61
	s_mul_i32 s23, s60, 0x1c0000
	s_mov_b32 s10, s14
	s_mov_b32 s11, s15
	s_mov_b32 s6, s28
	s_mov_b32 s7, s29
	s_mul_i32 s60, s70, 0x7000
	s_add_u32 s8, s69, s60
	s_xor_b32 s60, s70, 1
	s_mul_i32 s60, s60, 0x7000
	s_add_u32 s9, s69, s60
	s_mov_b32 s58, 0x5040100
	s_mov_b32 s59, 0x7060302
	s_barrier
	s_waitcnt vmcnt(30)
	v_perm_b32 v64, v33, v32, s58
	v_perm_b32 v68, v33, v32, s59
	s_waitcnt vmcnt(28)
	v_perm_b32 v65, v35, v34, s58
	v_perm_b32 v69, v35, v34, s59
	s_waitcnt vmcnt(26)
	v_perm_b32 v66, v37, v36, s58
	v_perm_b32 v70, v37, v36, s59
	s_waitcnt vmcnt(24)
	v_perm_b32 v67, v39, v38, s58
	v_perm_b32 v71, v39, v38, s59
	s_add_u32 s60, s55, 0
	buffer_store_dwordx4 v[64:67], v30, s[32:35], s60 offen sc1
	buffer_store_dwordx4 v[68:71], v30, s[32:35], s60 offen offset:1024 sc1
	s_waitcnt vmcnt(24)
	v_perm_b32 v72, v41, v40, s58
	v_perm_b32 v76, v41, v40, s59
	s_waitcnt vmcnt(22)
	v_perm_b32 v73, v43, v42, s58
	v_perm_b32 v77, v43, v42, s59
	s_waitcnt vmcnt(20)
	v_perm_b32 v74, v45, v44, s58
	v_perm_b32 v78, v45, v44, s59
	s_waitcnt vmcnt(18)
	v_perm_b32 v75, v47, v46, s58
	v_perm_b32 v79, v47, v46, s59
	s_add_u32 s60, s55, 0x800
	buffer_store_dwordx4 v[72:75], v30, s[32:35], s60 offen sc1
	buffer_store_dwordx4 v[76:79], v30, s[32:35], s60 offen offset:1024 sc1
	s_waitcnt vmcnt(18)
	v_perm_b32 v64, v49, v48, s58
	v_perm_b32 v68, v49, v48, s59
	s_waitcnt vmcnt(16)
	v_perm_b32 v65, v51, v50, s58
	v_perm_b32 v69, v51, v50, s59
	s_waitcnt vmcnt(14)
	v_perm_b32 v66, v53, v52, s58
	v_perm_b32 v70, v53, v52, s59
	s_waitcnt vmcnt(12)
	v_perm_b32 v67, v55, v54, s58
	v_perm_b32 v71, v55, v54, s59
	s_add_u32 s60, s55, 0x1000
	buffer_store_dwordx4 v[64:67], v30, s[32:35], s60 offen sc1
	buffer_store_dwordx4 v[68:71], v30, s[32:35], s60 offen offset:1024 sc1
	s_waitcnt vmcnt(12)
	v_perm_b32 v72, v57, v56, s58
	v_perm_b32 v76, v57, v56, s59
	s_waitcnt vmcnt(10)
	v_perm_b32 v73, v59, v58, s58
	v_perm_b32 v77, v59, v58, s59
	s_waitcnt vmcnt(8)
	v_perm_b32 v74, v61, v60, s58
	v_perm_b32 v78, v61, v60, s59
	s_waitcnt vmcnt(6)
	v_perm_b32 v75, v63, v62, s58
	v_perm_b32 v79, v63, v62, s59
	s_add_u32 s60, s55, 0x1800
	s_sub_u32 s60, s60, s54
	buffer_store_dwordx4 v[72:75], v30, s[32:35], s60 offen sc1
	buffer_store_dwordx4 v[76:79], v30, s[32:35], s60 offen offset:1024 sc1
sequential_preLN__spectral_gfnet__mixer_channel_mlp__prompt_kernel_hrb:
	v_mov_b32 v15, 0
	buffer_load_dword v14, v15, s[36:39], 0 offen offset:128 sc1
	s_cmp_eq_u32 s2, 0x78
	s_cbranch_scc1 sequential_preLN__spectral_gfnet__mixer_channel_mlp__prompt_kernel_bent
	s_waitcnt vmcnt(0)
	v_readfirstlane_b32 s60, v14
	s_nop 1
	s_cmp_ge_u32 s60, 1
	s_cbranch_scc1 sequential_preLN__spectral_gfnet__mixer_channel_mlp__prompt_kernel_zokh
	s_mov_b32 s62, 0x80000
sequential_preLN__spectral_gfnet__mixer_channel_mlp__prompt_kernel_zph:
	v_mov_b32 v15, 0
	buffer_load_dword v14, v15, s[36:39], 0 offen offset:128 sc1
	s_waitcnt vmcnt(0)
	v_readfirstlane_b32 s60, v14
	s_nop 1
	s_cmp_ge_u32 s60, 1
	s_cbranch_scc1 sequential_preLN__spectral_gfnet__mixer_channel_mlp__prompt_kernel_zokh
	s_sub_u32 s62, s62, 1
	s_cmp_lg_u32 s62, 0
	s_cbranch_scc1 sequential_preLN__spectral_gfnet__mixer_channel_mlp__prompt_kernel_zph
sequential_preLN__spectral_gfnet__mixer_channel_mlp__prompt_kernel_zokh:
	s_barrier
	s_cmp_lg_u32 s3, 0
	s_cbranch_scc1 sequential_preLN__spectral_gfnet__mixer_channel_mlp__prompt_kernel_na1h
	v_lshlrev_b32 v2, 10, v1
	v_mov_b32 v3, 0x10000000
	v_cmp_gt_u32 vcc, 32, v1
	s_nop 1
	v_cndmask_b32 v2, v3, v2, vcc
	s_and_b32 s60, s2, 7
	s_lshl_b32 s60, s60, 7
	s_add_u32 s60, s60, 0x30000
	buffer_atomic_add v9, v2, s[28:31], s60 offen sc1
sequential_preLN__spectral_gfnet__mixer_channel_mlp__prompt_kernel_na1h:
	s_mov_b32 s48, s10
	s_mov_b32 s49, s11
	s_mov_b32 s50, 0xe00
	s_mov_b32 s51, 0x20000
	s_lshl_b32 s60, s78, 8
	s_lshl_b32 s61, s3, 6
	s_add_u32 s60, s60, s61
	buffer_load_dwordx2 v[248:249], v10, s[48:51], s60 offen
	buffer_load_dwordx2 v[250:251], v10, s[48:51], s60 offen offset:16
	buffer_load_dwordx2 v[252:253], v10, s[48:51], s60 offen offset:32
	buffer_load_dwordx2 v[254:255], v10, s[48:51], s60 offen offset:48
	v_bfe_u32 v2, v1, 2, 2
	v_lshrrev_b32 v3, 5, v1
	v_lshl_add_u32 v3, v3, 4, v2
	v_lshlrev_b32 v14, 8, v3
	v_and_b32 v3, 3, v1
	v_lshl_add_u32 v14, v3, 3, v14
	v_bfe_u32 v3, v1, 4, 1
	v_lshl_add_u32 v14, v3, 5, v14
	v_xor_b32 v2, s3, v2
	v_lshl_add_u32 v14, v2, 6, v14
	v_add_u32 v15, 0x10000, v14
	s_lshl_b32 s80, s26, 3
	s_lshr_b32 s60, s27, 1
	s_add_u32 s80, s80, s60
	s_and_b32 s60, s80, 3
	s_lshl_b32 s81, s60, 4
	s_and_b32 s60, s27, 1
	s_lshl_b32 s60, s60, 3
	s_add_u32 s81, s81, s60
	s_lshl_b32 s60, s3, 1
	s_add_u32 s81, s81, s60
	s_lshl_b32 s81, s81, 5
	s_lshr_b32 s60, s80, 2
	s_add_u32 s81, s81, s60
	s_lshl_b32 s81, s81, 10
	s_add_u32 s61, s81, 0x8000
	v_lshlrev_b32 v24, 5, v4
	v_lshl_add_u32 v24, v5, 3, v24
	s_mov_b32 s56, s4
	s_mov_b32 s57, s5
	s_mov_b32 s58, 0x200000
	s_mov_b32 s59, 0x20000
	buffer_load_dwordx2 v[26:27], v24, s[56:59], s81 offen
	buffer_load_dwordx2 v[28:29], v24, s[56:59], s81 offen offset:512
	buffer_load_dwordx2 v[30:31], v24, s[56:59], s61 offen
	buffer_load_dwordx2 v[32:33], v24, s[56:59], s61 offen offset:512
	v_cvt_f32_u32 v25, v4
	s_add_u32 m0, s68, 0
	s_nop 0
	buffer_load_dwordx4 v11, s[44:47], s63 offen lds
	s_add_u32 s63, s63, 0xe000
	v_cvt_f32_u32 v34, v5
	v_mul_f32 v35, v25, v34
	v_cmp_gt_u32 s[80:81], 2, v5
	s_mov_b64 s[82:83], 0xffff
	v_cmp_eq_u32 s[84:85], 0, v4
	v_mul_f32 v36, 0x3e800000, v35
	v_mul_f32 v37, 0x3d800000, v25
	v_cos_f32 v38, v36
	v_sin_f32 v42, v36
	s_add_u32 m0, s68, 0x1000
	s_nop 0
	buffer_load_dwordx4 v11, s[44:47], s63 offen lds
	s_add_u32 s63, s63, 0xe000
	v_add_f32 v36, v36, v37
	v_cos_f32 v39, v36
	v_sin_f32 v43, v36
	v_add_f32 v36, v36, v37
	v_cos_f32 v40, v36
	v_sin_f32 v44, v36
	v_add_f32 v36, v36, v37
	v_cos_f32 v41, v36
	s_add_u32 m0, s68, 0x2000
	s_nop 0
	buffer_load_dwordx4 v11, s[44:47], s63 offen lds
	s_add_u32 s63, s63, 0xe000
	v_sin_f32 v45, v36
	v_mov_b32 v3, 0x80008000
	v_cndmask_b32 v2, v3, 0, s[80:81]
	v_xor_b32 v3, v3, v2
	v_cvt_pk_bf16_f32 v46, v38, v39
	v_cvt_pk_bf16_f32 v50, v42, v43
	v_xor_b32 v48, v50, v3
	v_xor_b32 v52, v46, v2
	s_add_u32 m0, s68, 0x3000
	s_nop 0
	buffer_load_dwordx4 v11, s[44:47], s63 offen lds
	s_add_u32 s63, s63, 0xe000
	v_cvt_pk_bf16_f32 v47, v40, v41
	v_cvt_pk_bf16_f32 v51, v44, v45
	v_xor_b32 v49, v51, v3
	v_xor_b32 v53, v47, v2
	v_mul_f32 v2, 0x41000000, v34
	v_add_f32 v3, 0xc1700000, v2
	v_cndmask_b32 v2, v3, v2, s[80:81]
	v_mul_f32 v36, v2, v25
	s_add_u32 m0, s68, 0x4000
	s_nop 0
	buffer_load_dwordx4 v11, s[44:47], s63 offen lds
	s_add_u32 s63, s63, 0xe000
	v_mul_f32 v36, 0x3d000000, v36
	v_cos_f32 v38, v36
	v_sin_f32 v42, v36
	v_add_f32 v36, v36, v37
	v_cos_f32 v39, v36
	v_sin_f32 v43, v36
	v_add_f32 v36, v36, v37
	v_cos_f32 v40, v36
	s_add_u32 m0, s68, 0x5000
	s_nop 0
	buffer_load_dwordx4 v11, s[44:47], s63 offen lds
	s_add_u32 s63, s63, 0xe000
	v_sin_f32 v44, v36
	v_add_f32 v36, v36, v37
	v_cos_f32 v41, v36
	v_sin_f32 v45, v36
	v_and_b32 v62, 1, v4
	v_lshlrev_b32 v62, 31, v62
	v_or_b32 v62, 1.0, v62
	v_mul_f32 v38, 2.0, v38
	s_add_u32 m0, s68, 0x6000
	s_nop 0
	buffer_load_dwordx4 v11, s[44:47], s63 offen lds
	s_add_u32 s63, s63, 0xe000
	v_mul_f32 v42, -2.0, v42
	v_mul_f32 v39, 2.0, v39
	v_mul_f32 v43, -2.0, v43
	v_mul_f32 v40, 2.0, v40
	v_mul_f32 v44, -2.0, v44
	v_mul_f32 v41, 2.0, v41
	v_mul_f32 v45, -2.0, v45
	v_cndmask_b32 v38, v38, 1.0, s[82:83]
	s_add_u32 m0, s68, 0x7000
	s_nop 0
	buffer_load_dwordx4 v11, s[44:47], s63 offen lds
	s_add_u32 s63, s63, 0xe000
	v_cndmask_b32 v42, v42, v62, s[82:83]
	v_cvt_pk_bf16_f32 v2, v38, v39
	v_cvt_pk_bf16_f32 v3, v42, v43
	v_cndmask_b32 v54, 0, v2, s[80:81]
	v_cndmask_b32 v58, v2, 0, s[80:81]
	v_cndmask_b32 v56, 0, v3, s[80:81]
	v_cndmask_b32 v60, v3, 0, s[80:81]
	v_cvt_pk_bf16_f32 v2, v40, v41
	s_add_u32 m0, s68, 0x8000
	s_nop 0
	buffer_load_dwordx4 v11, s[44:47], s63 offen lds
	s_add_u32 s63, s63, 0xe000
	v_cvt_pk_bf16_f32 v3, v44, v45
	v_cndmask_b32 v55, 0, v2, s[80:81]
	v_cndmask_b32 v59, v2, 0, s[80:81]
	v_cndmask_b32 v57, 0, v3, s[80:81]
	v_cndmask_b32 v61, v3, 0, s[80:81]
	v_mul_f32 v36, 0x3c000000, v35
	v_mul_f32 v37, 0x3b000000, v25
	v_cos_f32 v64, v36
	s_add_u32 m0, s68, 0x9000
	s_nop 0
	buffer_load_dwordx4 v11, s[44:47], s63 offen lds
	s_add_u32 s63, s63, 0xe000
	v_sin_f32 v68, v36
	v_add_f32 v36, v36, v37
	v_cos_f32 v65, v36
	v_sin_f32 v69, v36
	v_add_f32 v36, v36, v37
	v_cos_f32 v66, v36
	v_sin_f32 v70, v36
	v_add_f32 v36, v36, v37
	s_add_u32 m0, s68, 0xa000
	s_nop 0
	buffer_load_dwordx4 v11, s[44:47], s63 offen lds
	s_add_u32 s63, s63, 0xe000
	v_cos_f32 v67, v36
	v_sin_f32 v71, v36
	v_mul_f32 v64, 0x35800000, v64
	v_mul_f32 v68, 0x35800000, v68
	v_mul_f32 v65, 0x35800000, v65
	v_mul_f32 v69, 0x35800000, v69
	v_mul_f32 v66, 0x35800000, v66
	v_mul_f32 v70, 0x35800000, v70
	s_add_u32 m0, s68, 0xb000
	s_nop 0
	buffer_load_dwordx4 v11, s[44:47], s63 offen lds
	s_add_u32 s63, s63, 0xe000
	v_mul_f32 v67, 0x35800000, v67
	v_mul_f32 v71, 0x35800000, v71
	v_lshrrev_b32 v2, 2, v1
	v_lshlrev_b32 v63, 7, v2
	v_bfe_u32 v2, v1, 1, 1
	v_lshl_add_u32 v63, v2, 6, v63
	v_and_b32 v2, 1, v1
	v_lshl_add_u32 v63, v2, 4, v63
	s_add_u32 m0, s68, 0xc000
	s_nop 0
	buffer_load_dwordx4 v11, s[44:47], s63 offen lds
	s_add_u32 s63, s63, 0xe000
	s_lshl_b32 s86, s26, 3
	s_lshr_b32 s60, s27, 1
	s_add_u32 s86, s86, s60
	s_lshl_b32 s86, s86, 14
	s_lshl_b32 s60, s3, 12
	s_add_u32 s86, s86, s60
	s_and_b32 s60, s27, 1
	s_lshl_b32 s60, s60, 5
	s_add_u32 s86, s86, s60
	s_add_u32 s52, s24, 0x410000
	s_addc_u32 s53, s25, 0
	s_mov_b32 s54, 0x200000
	s_mov_b32 s55, 0x20000
	v_mul_f32 v36, 0x3e000000, v35
	v_mul_f32 v37, 0x3d000000, v25
	v_cos_f32 v38, v36
	v_sin_f32 v42, v36
	v_add_f32 v36, v36, v37
	v_cos_f32 v39, v36
	v_sin_f32 v43, v36
	v_add_f32 v36, v36, v37
	s_add_u32 m0, s68, 0xd000
	s_nop 0
	buffer_load_dwordx4 v11, s[44:47], s63 offen lds
	s_add_u32 s63, s63, 0xe000
	v_cos_f32 v40, v36
	v_sin_f32 v44, v36
	v_add_f32 v36, v36, v37
	v_cos_f32 v41, v36
	v_sin_f32 v45, v36
	v_mul_f32 v38, 2.0, v38
	v_mul_f32 v42, -2.0, v42
	v_mul_f32 v39, 2.0, v39
	s_add_u32 m0, s68, 0xe000
	s_nop 0
	buffer_load_dwordx4 v11, s[44:47], s63 offen lds
	s_add_u32 s63, s63, 0xe000
	v_mul_f32 v43, -2.0, v43
	v_mul_f32 v40, 2.0, v40
	v_mul_f32 v44, -2.0, v44
	v_mul_f32 v41, 2.0, v41
	v_mul_f32 v45, -2.0, v45
	v_cndmask_b32 v38, v38, 1.0, s[82:83]
	v_cndmask_b32 v42, v42, v62, s[82:83]
	v_cvt_pk_bf16_f32 v72, v38, v39
	s_add_u32 m0, s68, 0xf000
	s_nop 0
	buffer_load_dwordx4 v11, s[44:47], s63 offen lds
	s_add_u32 s63, s63, 0xe000
	v_cvt_pk_bf16_f32 v74, v42, v43
	v_cvt_pk_bf16_f32 v73, v40, v41
	v_cvt_pk_bf16_f32 v75, v44, v45
	v_xor_b32 v76, 0x80000000, v72
	v_xor_b32 v77, 0x80000000, v73
	v_xor_b32 v78, 0x80000000, v74
	v_xor_b32 v79, 0x80000000, v75
	v_lshl_add_u32 v2, v5, 7, v4
	s_xor_b32 s68, s68, 0x10000
	s_sub_u32 s63, s63, s23
	s_add_u32 m0, s68, 0
	s_nop 0
	buffer_load_dwordx4 v11, s[44:47], s63 offen lds
	s_add_u32 s63, s63, 0xe000
	v_sub_u32 v3, 0x200, v2
	v_cndmask_b32 v3, v3, v2, s[80:81]
	v_add_u32 v2, 0xffffff10, v2
	s_andn2_b64 vcc, s[84:85], s[80:81]
	v_cndmask_b32 v3, v3, v2, vcc
	s_lshr_b32 s60, s3, 1
	s_lshl_b32 s60, s60, 4
	s_and_b32 s61, s3, 1
	s_lshl_b32 s61, s61, 3
	s_add_u32 s60, s60, s61
	s_add_u32 s60, s60, 0x20000
	v_lshl_add_u32 v80, v3, 5, s60
	s_or_b64 vcc, s[84:85], s[80:81]
	v_mov_b32 v2, 0xfffffc00
	v_mov_b32 v3, 0x400
	v_cndmask_b32 v2, v2, v3, vcc
	s_add_u32 m0, s68, 0x1000
	s_nop 0
	buffer_load_dwordx4 v11, s[44:47], s63 offen lds
	s_add_u32 s63, s63, 0xe000
	v_add_u32 v81, v80, v2
	v_add_u32 v82, v81, v2
	v_add_u32 v83, v82, v2
	s_lshl_b32 s60, s3, 1
	v_add_u32 v2, s60, v1
	v_and_b32 v2, 7, v2
	v_lshlrev_b32 v2, 4, v2
	v_lshl_add_u32 v84, v1, 7, v2
	v_add_u32 v84, 0x22000, v84
	s_add_u32 m0, s68, 0x2000
	s_nop 0
	buffer_load_dwordx4 v11, s[44:47], s63 offen lds
	s_add_u32 s63, s63, 0xe000
	v_add_u32 v2, s60, v1
	v_add_u32 v2, 1, v2
	v_and_b32 v2, 7, v2
	v_lshlrev_b32 v2, 4, v2
	v_lshl_add_u32 v85, v1, 7, v2
	v_add_u32 v85, 0x22000, v85
	v_lshrrev_b32 v3, 3, v1
	v_add_u32 v2, v3, v1
	s_add_u32 m0, s68, 0x3000
	s_nop 0
	buffer_load_dwordx4 v11, s[44:47], s63 offen lds
	s_add_u32 s63, s63, 0xe000
	v_and_b32 v2, 7, v2
	v_lshlrev_b32 v2, 4, v2
	v_lshl_add_u32 v86, v3, 7, v2
	s_lshl_b32 s60, s3, 11
	s_add_u32 s60, s60, 0x22000
	v_add_u32 v86, s60, v86
	s_add_u32 s36, s24, 0x610000
	s_addc_u32 s37, s25, 0
	s_mov_b32 s38, 0x200000
	s_mov_b32 s39, 0x20000
	s_add_u32 s40, s24, 0x810000
	s_addc_u32 s41, s25, 0
	s_mov_b32 s42, 0x200000
	s_mov_b32 s43, 0x20000
	s_lshl_b32 s60, s26, 4
	s_add_u32 s60, s60, s27
	s_lshl_b32 s88, s60, 13
	s_lshl_b32 s61, s3, 11
	s_add_u32 s88, s88, s61
	s_add_u32 s89, s88, 0x400
	v_lshlrev_b32 v87, 4, v1
	s_mov_b32 s90, 0x5040100
	s_mov_b32 s91, 0x7060302
	s_add_u32 m0, s68, 0x4000
	s_nop 0
	buffer_load_dwordx4 v11, s[44:47], s63 offen lds
	s_add_u32 s63, s63, 0xe000
	s_add_u32 m0, s68, 0x5000
	s_nop 0
	buffer_load_dwordx4 v11, s[44:47], s63 offen lds
	s_add_u32 s63, s63, 0xe000
	s_add_u32 m0, s68, 0x6000
	s_nop 0
	buffer_load_dwordx4 v11, s[44:47], s63 offen lds
	s_add_u32 s63, s63, 0xe000
	s_add_u32 m0, s68, 0x7000
	s_nop 0
	buffer_load_dwordx4 v11, s[44:47], s63 offen lds
	s_add_u32 s63, s63, 0xe000
	s_add_u32 m0, s68, 0x8000
	s_nop 0
	buffer_load_dwordx4 v11, s[44:47], s63 offen lds
	s_add_u32 s63, s63, 0xe000
	s_add_u32 m0, s68, 0x9000
	s_nop 0
	buffer_load_dwordx4 v11, s[44:47], s63 offen lds
	s_add_u32 s63, s63, 0xe000
	s_add_u32 m0, s68, 0xa000
	s_nop 0
	buffer_load_dwordx4 v11, s[44:47], s63 offen lds
	s_add_u32 s63, s63, 0xe000
	s_add_u32 m0, s68, 0xb000
	s_nop 0
	buffer_load_dwordx4 v11, s[44:47], s63 offen lds
	s_add_u32 s63, s63, 0xe000
	s_add_u32 m0, s68, 0xc000
	s_nop 0
	buffer_load_dwordx4 v11, s[44:47], s63 offen lds
	s_add_u32 s63, s63, 0xe000
	s_add_u32 m0, s68, 0xd000
	s_nop 0
	buffer_load_dwordx4 v11, s[44:47], s63 offen lds
	s_add_u32 s63, s63, 0xe000
	s_add_u32 m0, s68, 0xe000
	s_nop 0
	buffer_load_dwordx4 v11, s[44:47], s63 offen lds
	s_add_u32 s63, s63, 0xe000
	s_add_u32 m0, s68, 0xf000
	s_nop 0
	buffer_load_dwordx4 v11, s[44:47], s63 offen lds
	s_cmp_lg_u32 s3, 0
	s_cbranch_scc1 sequential_preLN__spectral_gfnet__mixer_channel_mlp__prompt_kernel_nph1
	s_waitcnt lgkmcnt(0)
	s_and_b32 s61, s2, 31
	s_lshl_b32 s61, s61, 10
	s_add_u32 s61, s61, 0x30000
	s_add_u32 s16, s6, s61
	s_addc_u32 s17, s7, 0
	s_mov_b32 s62, 0x80000
sequential_preLN__spectral_gfnet__mixer_channel_mlp__prompt_kernel_pollyh1:
	s_load_dword s64, s[16:17], 0 glc
	s_load_dword s65, s[16:17], 0x80 glc
	s_load_dword s66, s[16:17], 0x100 glc
	s_load_dword s67, s[16:17], 0x180 glc
	s_load_dword s12, s[16:17], 0x200 glc
	s_load_dword s13, s[16:17], 0x280 glc
	s_load_dword s14, s[16:17], 0x300 glc
	s_load_dword s15, s[16:17], 0x380 glc
	s_waitcnt lgkmcnt(0)
	s_min_u32 s64, s64, s65
	s_min_u32 s66, s66, s67
	s_min_u32 s12, s12, s13
	s_min_u32 s14, s14, s15
	s_min_u32 s64, s64, s66
	s_min_u32 s12, s12, s14
	s_min_u32 s64, s64, s12
	s_cmp_ge_u32 s64, 32
	s_cbranch_scc1 sequential_preLN__spectral_gfnet__mixer_channel_mlp__prompt_kernel_nph1
	s_sub_u32 s62, s62, 1
	s_cmp_lg_u32 s62, 0
	s_cbranch_scc1 sequential_preLN__spectral_gfnet__mixer_channel_mlp__prompt_kernel_pollyh1
sequential_preLN__spectral_gfnet__mixer_channel_mlp__prompt_kernel_nph1:
	s_barrier
	s_add_u32 s69, s8, 0
	buffer_load_dwordx4 a[128:131], v12, s[32:35], s69 offen sc1
	buffer_load_dwordx4 a[132:135], v12, s[32:35], s69 offen offset:1024 sc1
	buffer_load_dwordx4 a[136:139], v12, s[32:35], s69 offen offset:2048 sc1
	buffer_load_dwordx4 a[140:143], v12, s[32:35], s69 offen offset:3072 sc1
	s_add_u32 s69, s8, 0x1000
	buffer_load_dwordx4 a[144:147], v12, s[32:35], s69 offen sc1
	s_waitcnt vmcnt(5)
	s_barrier
	ds_read_b64_tr_b16 a[0:1], v14 offset:0
	ds_read_b64_tr_b16 a[2:3], v15 offset:0
	ds_read_b64_tr_b16 a[4:5], v14 offset:8192
	ds_read_b64_tr_b16 a[6:7], v15 offset:8192
	ds_read_b64_tr_b16 a[8:9], v14 offset:16384
	ds_read_b64_tr_b16 a[10:11], v15 offset:16384
	ds_read_b64_tr_b16 a[12:13], v14 offset:24576
	ds_read_b64_tr_b16 a[14:15], v15 offset:24576
	ds_read_b64_tr_b16 a[16:17], v14 offset:32768
	ds_read_b64_tr_b16 a[18:19], v15 offset:32768
	ds_read_b64_tr_b16 a[20:21], v14 offset:40960
	ds_read_b64_tr_b16 a[22:23], v15 offset:40960
	ds_read_b64_tr_b16 a[24:25], v14 offset:49152
	ds_read_b64_tr_b16 a[26:27], v15 offset:49152
	ds_read_b64_tr_b16 a[28:29], v14 offset:57344
	ds_read_b64_tr_b16 a[30:31], v15 offset:57344
	ds_read_b64_tr_b16 a[32:33], v14 offset:1024
	ds_read_b64_tr_b16 a[34:35], v15 offset:1024
	ds_read_b64_tr_b16 a[36:37], v14 offset:9216
	ds_read_b64_tr_b16 a[38:39], v15 offset:9216
	ds_read_b64_tr_b16 a[40:41], v14 offset:17408
	ds_read_b64_tr_b16 a[42:43], v15 offset:17408
	ds_read_b64_tr_b16 a[44:45], v14 offset:25600
	ds_read_b64_tr_b16 a[46:47], v15 offset:25600
	ds_read_b64_tr_b16 a[48:49], v14 offset:33792
	ds_read_b64_tr_b16 a[50:51], v15 offset:33792
	ds_read_b64_tr_b16 a[52:53], v14 offset:41984
	ds_read_b64_tr_b16 a[54:55], v15 offset:41984
	ds_read_b64_tr_b16 a[56:57], v14 offset:50176
	ds_read_b64_tr_b16 a[58:59], v15 offset:50176
	ds_read_b64_tr_b16 a[60:61], v14 offset:58368
	ds_read_b64_tr_b16 a[62:63], v15 offset:58368
	ds_read_b64_tr_b16 a[64:65], v14 offset:2048
	ds_read_b64_tr_b16 a[66:67], v15 offset:2048
	ds_read_b64_tr_b16 a[68:69], v14 offset:10240
	ds_read_b64_tr_b16 a[70:71], v15 offset:10240
	ds_read_b64_tr_b16 a[72:73], v14 offset:18432
	ds_read_b64_tr_b16 a[74:75], v15 offset:18432
	ds_read_b64_tr_b16 a[76:77], v14 offset:26624
	ds_read_b64_tr_b16 a[78:79], v15 offset:26624
	ds_read_b64_tr_b16 a[80:81], v14 offset:34816
	ds_read_b64_tr_b16 a[82:83], v15 offset:34816
	ds_read_b64_tr_b16 a[84:85], v14 offset:43008
	ds_read_b64_tr_b16 a[86:87], v15 offset:43008
	ds_read_b64_tr_b16 a[88:89], v14 offset:51200
	ds_read_b64_tr_b16 a[90:91], v15 offset:51200
	ds_read_b64_tr_b16 a[92:93], v14 offset:59392
	ds_read_b64_tr_b16 a[94:95], v15 offset:59392
	ds_read_b64_tr_b16 a[96:97], v14 offset:3072
	ds_read_b64_tr_b16 a[98:99], v15 offset:3072
	ds_read_b64_tr_b16 a[100:101], v14 offset:11264
	ds_read_b64_tr_b16 a[102:103], v15 offset:11264
	ds_read_b64_tr_b16 a[104:105], v14 offset:19456
	ds_read_b64_tr_b16 a[106:107], v15 offset:19456
	ds_read_b64_tr_b16 a[108:109], v14 offset:27648
	ds_read_b64_tr_b16 a[110:111], v15 offset:27648
	ds_read_b64_tr_b16 a[112:113], v14 offset:35840
	ds_read_b64_tr_b16 a[114:115], v15 offset:35840
	ds_read_b64_tr_b16 a[116:117], v14 offset:44032
	ds_read_b64_tr_b16 a[118:119], v15 offset:44032
	ds_read_b64_tr_b16 a[120:121], v14 offset:52224
	ds_read_b64_tr_b16 a[122:123], v15 offset:52224
	ds_read_b64_tr_b16 a[124:125], v14 offset:60416
	ds_read_b64_tr_b16 a[126:127], v15 offset:60416
	buffer_load_dwordx4 a[148:151], v12, s[32:35], s69 offen offset:1024 sc1
	buffer_load_dwordx4 a[152:155], v12, s[32:35], s69 offen offset:2048 sc1
	buffer_load_dwordx4 a[156:159], v12, s[32:35], s69 offen offset:3072 sc1
	s_waitcnt vmcnt(7)
	s_add_u32 s69, s8, 0x2000
	buffer_load_dwordx4 a[160:163], v12, s[32:35], s69 offen sc1
	s_waitcnt vmcnt(7)
	buffer_load_dwordx4 a[164:167], v12, s[32:35], s69 offen offset:1024 sc1
	s_waitcnt vmcnt(7)
	buffer_load_dwordx4 a[168:171], v12, s[32:35], s69 offen offset:2048 sc1
	s_waitcnt vmcnt(7)
	buffer_load_dwordx4 a[172:175], v12, s[32:35], s69 offen offset:3072 sc1
	s_waitcnt vmcnt(7)
	s_add_u32 s69, s8, 0x3000
	buffer_load_dwordx4 a[176:179], v12, s[32:35], s69 offen sc1
	s_waitcnt vmcnt(7)
	buffer_load_dwordx4 a[180:183], v12, s[32:35], s69 offen offset:1024 sc1
	s_waitcnt vmcnt(7)
	buffer_load_dwordx4 a[184:187], v12, s[32:35], s69 offen offset:2048 sc1
	s_waitcnt vmcnt(7)
	buffer_load_dwordx4 a[188:191], v12, s[32:35], s69 offen offset:3072 sc1
	s_waitcnt vmcnt(7)
	s_add_u32 s69, s8, 0x4000
	buffer_load_dwordx4 a[192:195], v12, s[32:35], s69 offen sc1
	s_waitcnt vmcnt(7)
	buffer_load_dwordx4 a[196:199], v12, s[32:35], s69 offen offset:1024 sc1
	s_waitcnt vmcnt(7)
	buffer_load_dwordx4 a[200:203], v12, s[32:35], s69 offen offset:2048 sc1
	s_waitcnt vmcnt(7)
	buffer_load_dwordx4 a[204:207], v12, s[32:35], s69 offen offset:3072 sc1
	s_waitcnt vmcnt(7)
	s_add_u32 s69, s8, 0x5000
	buffer_load_dwordx4 a[208:211], v12, s[32:35], s69 offen sc1
	s_waitcnt vmcnt(7)
	buffer_load_dwordx4 a[212:215], v12, s[32:35], s69 offen offset:1024 sc1
	s_waitcnt vmcnt(7)
	buffer_load_dwordx4 a[216:219], v12, s[32:35], s69 offen offset:2048 sc1
	s_waitcnt vmcnt(7)
	buffer_load_dwordx4 a[220:223], v12, s[32:35], s69 offen offset:3072 sc1
	s_waitcnt vmcnt(7)
	s_add_u32 s69, s8, 0x6000
	buffer_load_dwordx4 a[224:227], v12, s[32:35], s69 offen sc1
	s_waitcnt vmcnt(7)
	buffer_load_dwordx4 a[228:231], v12, s[32:35], s69 offen offset:1024 sc1
	s_waitcnt vmcnt(7)
	buffer_load_dwordx4 a[232:235], v12, s[32:35], s69 offen offset:2048 sc1
	s_waitcnt vmcnt(7)
	buffer_load_dwordx4 a[236:239], v12, s[32:35], s69 offen offset:3072 sc1
	v_lshlrev_b32 v184, 16, v26
	v_and_b32 v185, 0xffff0000, v26
	v_lshlrev_b32 v186, 16, v27
	v_and_b32 v187, 0xffff0000, v27
	v_lshlrev_b32 v188, 16, v28
	v_and_b32 v189, 0xffff0000, v28
	v_lshlrev_b32 v190, 16, v29
	v_and_b32 v191, 0xffff0000, v29
	v_lshlrev_b32 v192, 16, v30
	v_and_b32 v193, 0xffff0000, v30
	v_lshlrev_b32 v194, 16, v31
	v_and_b32 v195, 0xffff0000, v31
	v_lshlrev_b32 v196, 16, v32
	v_and_b32 v197, 0xffff0000, v32
	v_lshlrev_b32 v198, 16, v33
	v_and_b32 v199, 0xffff0000, v33
	v_lshlrev_b32 v240, 16, v248
	v_and_b32 v241, 0xffff0000, v248
	v_lshlrev_b32 v242, 16, v249
	v_and_b32 v243, 0xffff0000, v249
	v_lshlrev_b32 v244, 16, v250
	v_and_b32 v245, 0xffff0000, v250
	v_lshlrev_b32 v246, 16, v251
	v_and_b32 v247, 0xffff0000, v251
	v_lshlrev_b32 v248, 16, v252
	v_and_b32 v249, 0xffff0000, v252
	v_lshlrev_b32 v250, 16, v253
	v_and_b32 v251, 0xffff0000, v253
	v_lshlrev_b32 v252, 16, v254
	v_and_b32 v253, 0xffff0000, v254
	v_lshlrev_b32 v254, 16, v255
	v_and_b32 v255, 0xffff0000, v255
	s_cmp_lg_u32 s3, 0
	s_cbranch_scc1 sequential_preLN__spectral_gfnet__mixer_channel_mlp__prompt_kernel_nph
	s_waitcnt lgkmcnt(0)
	s_and_b32 s61, s2, 31
	s_lshl_b32 s61, s61, 10
	s_add_u32 s61, s61, 0x28000
	s_add_u32 s16, s6, s61
	s_addc_u32 s17, s7, 0
	s_mov_b32 s62, 0x80000
sequential_preLN__spectral_gfnet__mixer_channel_mlp__prompt_kernel_pollyh:
	s_load_dword s64, s[16:17], 0 glc
	s_load_dword s65, s[16:17], 0x80 glc
	s_load_dword s66, s[16:17], 0x100 glc
	s_load_dword s67, s[16:17], 0x180 glc
	s_load_dword s12, s[16:17], 0x200 glc
	s_load_dword s13, s[16:17], 0x280 glc
	s_load_dword s14, s[16:17], 0x300 glc
	s_load_dword s15, s[16:17], 0x380 glc
	s_waitcnt lgkmcnt(0)
	s_sub_u32 s64, s64, 1
	s_cmp_eq_u32 s64, -1
	s_cselect_b32 s64, 0, s64
	s_min_u32 s64, s64, s65
	s_min_u32 s66, s66, s67
	s_min_u32 s12, s12, s13
	s_min_u32 s14, s14, s15
	s_min_u32 s64, s64, s66
	s_min_u32 s12, s12, s14
	s_min_u32 s64, s64, s12
	s_cmp_ge_u32 s64, 16
	s_cbranch_scc1 sequential_preLN__spectral_gfnet__mixer_channel_mlp__prompt_kernel_nph
	s_sub_u32 s62, s62, 1
	s_cmp_lg_u32 s62, 0
	s_cbranch_scc1 sequential_preLN__spectral_gfnet__mixer_channel_mlp__prompt_kernel_pollyh
sequential_preLN__spectral_gfnet__mixer_channel_mlp__prompt_kernel_nph:
	s_barrier
	s_lshl_b32 s60, s3, 11
	s_add_u32 m0, s60, 0x20000
	s_nop 0
	buffer_load_dwordx4 v63, s[52:55], s86 offen sc1 lds
	s_add_u32 m0, m0, 0x400
	s_add_u32 s61, s86, 0x800
	buffer_load_dwordx4 v63, s[52:55], s61 offen sc1 lds
	s_waitcnt vmcnt(0)
	s_barrier
	ds_read_b64 v[224:225], v80
	ds_read_b64 v[226:227], v81
	ds_read_b64 v[228:229], v82
	ds_read_b64 v[230:231], v83
	s_waitcnt lgkmcnt(2)
	v_perm_b32 v200, v226, v224, s90
	s_waitcnt lgkmcnt(0)
	v_perm_b32 v201, v230, v228, s90
	v_perm_b32 v202, v227, v225, s90
	v_perm_b32 v203, v231, v229, s90
	s_nop 1
	v_mfma_f32_16x16x32_bf16 v[208:211], v[200:203], v[46:49], 0
	v_mfma_f32_16x16x32_bf16 v[212:215], v[200:203], v[50:53], 0
	v_mfma_f32_16x16x32_bf16 v[216:219], v[200:203], v[54:57], 0
	v_mfma_f32_16x16x32_bf16 v[220:223], v[200:203], v[58:61], 0
	v_perm_b32 v204, v226, v224, s91
	v_perm_b32 v205, v230, v228, s91
	v_perm_b32 v206, v227, v225, s91
	v_perm_b32 v207, v231, v229, s91
	s_nop 1
	v_mfma_f32_16x16x32_bf16 v[224:227], v[204:207], v[46:49], 0
	v_mfma_f32_16x16x32_bf16 v[228:231], v[204:207], v[50:53], 0
	v_mfma_f32_16x16x32_bf16 v[232:235], v[204:207], v[54:57], 0
	v_mfma_f32_16x16x32_bf16 v[236:239], v[204:207], v[58:61], 0
	v_mul_f32 v39, v209, v65
	v_mul_f32 v43, v213, v65
	v_fma_f32 v39, -v213, v69, v39
	v_fmac_f32 v43, v209, v69
	v_mul_f32 v40, v210, v66
	v_mul_f32 v44, v214, v66
	v_fma_f32 v40, -v214, v70, v40
	v_fmac_f32 v44, v210, v70
	v_mul_f32 v41, v211, v67
	v_mul_f32 v45, v215, v67
	v_fma_f32 v41, -v215, v71, v41
	v_fmac_f32 v45, v211, v71
	v_cndmask_b32 v208, v208, v216, s[82:83]
	v_cndmask_b32 v212, v212, v220, s[82:83]
	v_mul_f32 v38, v208, v64
	v_mul_f32 v42, v212, v64
	v_fma_f32 v38, -v212, v68, v38
	v_fmac_f32 v42, v208, v68
	v_cvt_pk_bf16_f32 v200, v38, v39
	v_cvt_pk_bf16_f32 v201, v40, v41
	v_cvt_pk_bf16_f32 v202, v42, v43
	v_cvt_pk_bf16_f32 v203, v44, v45
	s_nop 1
	v_mfma_f32_16x16x32_bf16 v[184:187], v[200:203], v[72:75], v[184:187]
	v_mfma_f32_16x16x32_bf16 v[188:191], v[200:203], v[76:79], v[188:191]
	v_mul_f32 v39, v225, v65
	v_mul_f32 v43, v229, v65
	v_fma_f32 v39, -v229, v69, v39
	v_fmac_f32 v43, v225, v69
	v_mul_f32 v40, v226, v66
	v_mul_f32 v44, v230, v66
	v_fma_f32 v40, -v230, v70, v40
	v_fmac_f32 v44, v226, v70
	v_mul_f32 v41, v227, v67
	v_mul_f32 v45, v231, v67
	v_fma_f32 v41, -v231, v71, v41
	v_fmac_f32 v45, v227, v71
	v_cndmask_b32 v224, v224, v232, s[82:83]
	v_cndmask_b32 v228, v228, v236, s[82:83]
	v_mul_f32 v38, v224, v64
	v_mul_f32 v42, v228, v64
	v_fma_f32 v38, -v228, v68, v38
	v_fmac_f32 v42, v224, v68
	v_cvt_pk_bf16_f32 v204, v38, v39
	v_cvt_pk_bf16_f32 v205, v40, v41
	v_cvt_pk_bf16_f32 v206, v42, v43
	v_cvt_pk_bf16_f32 v207, v44, v45
	s_nop 1
	v_mfma_f32_16x16x32_bf16 v[192:195], v[204:207], v[72:75], v[192:195]
	v_mfma_f32_16x16x32_bf16 v[196:199], v[204:207], v[76:79], v[196:199]
	v_mov_b32 v224, 0x3f803f80
	v_cvt_pk_bf16_f32 v26, v184, v185
	v_cvt_pk_bf16_f32 v27, v186, v187
	v_cvt_pk_bf16_f32 v28, v188, v189
	v_cvt_pk_bf16_f32 v29, v190, v191
	s_nop 1
	v_cvt_pk_bf16_f32 v30, v192, v193
	v_cvt_pk_bf16_f32 v31, v194, v195
	v_cvt_pk_bf16_f32 v32, v196, v197
	v_cvt_pk_bf16_f32 v33, v198, v199
	v_dot2_f32_bf16 v225, v26, v224, 0
	v_dot2_f32_bf16 v226, v26, v26, 0
	v_dot2_f32_bf16 v227, v30, v224, 0
	v_dot2_f32_bf16 v228, v30, v30, 0
	v_dot2_f32_bf16 v225, v27, v224, v225
	v_dot2_f32_bf16 v226, v27, v27, v226
	v_dot2_f32_bf16 v227, v31, v224, v227
	v_dot2_f32_bf16 v228, v31, v31, v228
	v_dot2_f32_bf16 v225, v28, v224, v225
	v_dot2_f32_bf16 v226, v28, v28, v226
	v_dot2_f32_bf16 v227, v32, v224, v227
	v_dot2_f32_bf16 v228, v32, v32, v228
	v_dot2_f32_bf16 v225, v29, v224, v225
	v_dot2_f32_bf16 v226, v29, v29, v226
	v_dot2_f32_bf16 v227, v33, v224, v227
	v_dot2_f32_bf16 v228, v33, v33, v228
	s_nop 2
	v_permlane32_swap_b32 v225, v227
	v_permlane32_swap_b32 v226, v228
	v_add_f32 v225, v225, v227
	v_add_f32 v226, v226, v228
	s_nop 1
	v_permlane16_swap_b32 v225, v226
	v_add_f32 v225, v225, v226
	s_nop 1
	v_add_f32_dpp v225, v225, v225 row_ror:1 row_mask:0xf bank_mask:0xf
	s_nop 1
	v_add_f32_dpp v225, v225, v225 row_ror:2 row_mask:0xf bank_mask:0xf
	s_nop 1
	v_add_f32_dpp v225, v225, v225 row_ror:4 row_mask:0xf bank_mask:0xf
	s_nop 1
	v_add_f32_dpp v225, v225, v225 row_ror:8 row_mask:0xf bank_mask:0xf
	v_mov_b32 v226, v225
	s_nop 1
	v_permlane16_swap_b32 v225, v226
	v_mul_f32 v225, 0x3b000000, v225
	v_mul_f32 v226, 0x3b000000, v226
	v_fma_f32 v226, -v225, v225, v226
	v_max_f32 v226, 0, v226
	v_cvt_pk_bf16_f32 v229, v225, v225
	v_lshlrev_b32 v229, 16, v229
	v_cvt_pk_bf16_f32 v230, v226, v226
	v_lshlrev_b32 v230, 16, v230
	v_add_f32 v230, 0x3727c5ac, v230
	v_cvt_pk_bf16_f32 v230, v230, v230
	v_lshlrev_b32 v230, 16, v230
	v_sqrt_f32 v230, v230
	s_nop 0
	v_cvt_pk_bf16_f32 v230, v230, v230
	v_lshlrev_b32 v230, 16, v230
	v_rcp_f32 v230, v230
	v_sub_f32 v231, v225, v229
	v_mul_f32 v231, v231, v230
	v_cvt_pk_bf16_f32 v231, v231, v231
	v_lshlrev_b32 v231, 16, v231
	v_mul_f32 v226, v226, v230
	v_mul_f32 v226, v226, v230
	v_cvt_pk_bf16_f32 v227, v226, v226
	v_lshlrev_b32 v227, 16, v227
	v_add_f32 v227, 0x3727c5ac, v227
	v_cvt_pk_bf16_f32 v227, v227, v227
	v_lshlrev_b32 v227, 16, v227
	v_sqrt_f32 v227, v227
	s_nop 0
	v_cvt_pk_bf16_f32 v227, v227, v227
	v_lshlrev_b32 v227, 16, v227
	v_rcp_f32 v227, v227
	v_fmac_f32 v231, v229, v230
	v_mul_f32 v231, v231, v227
	v_mul_f32 v230, v230, v227
	v_mov_b32 v2, v230
	v_mov_b32 v3, v231
	s_nop 0
	v_permlane32_swap_b32 v230, v2
	v_permlane32_swap_b32 v231, v3
	v_fma_f32 v184, v184, v230, -v231
	v_fma_f32 v185, v185, v230, -v231
	v_fma_f32 v186, v186, v230, -v231
	v_fma_f32 v187, v187, v230, -v231
	v_fma_f32 v188, v188, v230, -v231
	v_fma_f32 v189, v189, v230, -v231
	v_fma_f32 v190, v190, v230, -v231
	v_fma_f32 v191, v191, v230, -v231
	v_cvt_pk_bf16_f32 v200, v184, v185
	v_cvt_pk_bf16_f32 v201, v186, v187
	v_cvt_pk_bf16_f32 v202, v188, v189
	v_cvt_pk_bf16_f32 v203, v190, v191
	ds_write_b128 v84, v[200:203]
	v_fma_f32 v192, v192, v2, -v3
	v_fma_f32 v193, v193, v2, -v3
	v_fma_f32 v194, v194, v2, -v3
	v_fma_f32 v195, v195, v2, -v3
	v_fma_f32 v196, v196, v2, -v3
	v_fma_f32 v197, v197, v2, -v3
	v_fma_f32 v198, v198, v2, -v3
	v_fma_f32 v199, v199, v2, -v3
	v_cvt_pk_bf16_f32 v204, v192, v193
	v_cvt_pk_bf16_f32 v205, v194, v195
	v_cvt_pk_bf16_f32 v206, v196, v197
	v_cvt_pk_bf16_f32 v207, v198, v199
	ds_write_b128 v85, v[204:207]
	s_waitcnt lgkmcnt(0)
	s_barrier
	ds_read_b128 v[208:211], v86
	ds_read_b128 v[212:215], v86 offset:1024
	s_waitcnt lgkmcnt(1)
	buffer_store_dwordx4 v[208:211], v87, s[40:43], s88 offen sc1
	s_waitcnt lgkmcnt(0)
	buffer_store_dwordx4 v[212:215], v87, s[40:43], s89 offen sc1
	buffer_store_dwordx2 v[26:27], v24, s[36:39], s88 offen sc1
	buffer_store_dwordx2 v[28:29], v24, s[36:39], s88 offen offset:512 sc1
	buffer_store_dwordx2 v[30:31], v24, s[36:39], s89 offen sc1
	buffer_store_dwordx2 v[32:33], v24, s[36:39], s89 offen offset:512 sc1
	s_waitcnt vmcnt(0)
	s_barrier
	s_cmp_lg_u32 s3, 0
	s_cbranch_scc1 sequential_preLN__spectral_gfnet__mixer_channel_mlp__prompt_kernel_nosigh
	s_lshl_b32 s60, s26, 11
	s_and_b32 s61, s27, 12
	s_add_u32 s60, s60, s61
	buffer_atomic_add v9, v8, s[28:31], s60 offen sc1
sequential_preLN__spectral_gfnet__mixer_channel_mlp__prompt_kernel_nosigh:
	s_waitcnt vmcnt(7) lgkmcnt(0)
	s_branch sequential_preLN__spectral_gfnet__mixer_channel_mlp__prompt_kernel_join_h
sequential_preLN__spectral_gfnet__mixer_channel_mlp__prompt_kernel_fast_end:
sequential_preLN__spectral_gfnet__mixer_channel_mlp__prompt_kernel_end:
	s_endpgm
.section .rodata,"a"
.p2align 6
.amdhsa_kernel sequential_preLN__spectral_gfnet__mixer_channel_mlp__prompt_kernel
  .amdhsa_next_free_vgpr 512
  .amdhsa_next_free_sgpr 102
  .amdhsa_accum_offset 256
  .amdhsa_group_segment_fixed_size 0
  .amdhsa_kernarg_size 88
  .amdhsa_user_sgpr_count 2
  .amdhsa_user_sgpr_kernarg_segment_ptr 1
  .amdhsa_system_sgpr_workgroup_id_x 1
  .amdhsa_float_denorm_mode_32 3
.end_amdhsa_kernel
.text
```
